```python
import torch

def _softmax(x, axis=-1):
    return torch.softmax(x, dim=axis)
def _gelu(x):
    return torch.nn.functional.gelu(x, approximate="tanh")
def _silu(x):
    return torch.nn.functional.silu(x)
def _sigmoid(x):
    return torch.sigmoid(x)
def _layernorm(x, axis=-1, eps=1e-5):
    m = x.mean(dim=axis, keepdim=True)
    v = x.var(dim=axis, keepdim=True, unbiased=False)
    return (x - m) / torch.sqrt(v + eps)
def _scatter_add(tgt, idx, src, axis=0):
    return tgt.clone().index_add_(axis, idx, src)
def _segment_sum(src, seg, n):
    out = torch.zeros((n,) + src.shape[1:], dtype=src.dtype)
    return out.index_add_(0, seg, src)
def _pad(x, pw):
    flat = tuple(v for pair in reversed(pw) for v in pair)
    return torch.nn.functional.pad(x, flat)

kernel_name = 'parallel_sum__mha_block_cached__mixer_token_mlp__decode'

def setup_inputs():

    _w = (lambda a: (lambda t: t.to(torch.bfloat16) if t.is_floating_point() else t)(torch.as_tensor(a)))
    def _A_setup():
        B, Sq, D = 1, 1, 512
        H, Sk, Dh = 32, 32768, 128
        return {
            "x": _w((lambda *s: torch.randn(*s, dtype=torch.bfloat16) * 0.05)(B, Sq, D)),
            "k_cache": _w((lambda *s: torch.randn(*s, dtype=torch.bfloat16) * 3.2)(B, H, Sk, Dh)),
            "v_cache": _w((lambda *s: torch.randn(*s, dtype=torch.bfloat16) * 0.8)(B, H, Sk, Dh)),
            "wq": _w((lambda *s: torch.randn(*s, dtype=torch.bfloat16) * 3.2)(D, H * Dh) * (D ** -0.5)),
            "wo": _w((lambda *s: torch.randn(*s, dtype=torch.bfloat16) * 0.8)(H * Dh, D) * ((H * Dh) ** -0.5)),
        }
    _A_in = _A_setup()

    def _B_setup():
        B, S, D, F = 1, 1, 512, 1792
        return {
            "x": _w((lambda *s: torch.randn(*s, dtype=torch.bfloat16) * 0.05)(B, S, D)),
            "w1": _w((lambda *s: torch.randn(*s, dtype=torch.bfloat16) * 3.2)(S, F) * (S ** -0.5)),
            "b1": _w((lambda *s: torch.randn(*s, dtype=torch.bfloat16) * 3.2)(F) * 0.02),
            "w2": _w((lambda *s: torch.randn(*s, dtype=torch.bfloat16) * 0.4)(F, S) * (F ** -0.5)),
            "b2": _w((lambda *s: torch.randn(*s, dtype=torch.bfloat16) * 0.4)(S) * 0.02),
        }
    _B_in = _B_setup()

    return {
        "A_x": _A_in["x"],
        "A_k_cache": _A_in["k_cache"],
        "A_v_cache": _A_in["v_cache"],
        "A_wq": _A_in["wq"],
        "A_wo": _A_in["wo"],
        "B_x": _B_in["x"],
        "B_w1": _B_in["w1"],
        "B_b1": _B_in["b1"],
        "B_w2": _B_in["w2"],
        "B_b2": _B_in["b2"],
    }

def reference(A_x, A_k_cache, A_v_cache, A_wq, A_wo, B_x, B_w1, B_b1, B_w2, B_b2):
    def _A_ref(x, k_cache, v_cache, wq, wo):
        B, Sq, D = x.shape
        H, Dh = 32, 128
        q = (lambda x, *d: x.permute(*d))((x @ wq).reshape(B, Sq, H, Dh), 0, 2, 1, 3)
        scores = torch.einsum("bhqd,bhkd->bhqk", q, k_cache) * (Dh ** -0.5)
        p = _softmax(scores, axis=-1)
        o = torch.einsum("bhqk,bhkd->bhqd", p, v_cache)
        return (lambda x, *d: x.permute(*d))(o, 0, 2, 1, 3).reshape(B, Sq, H * Dh) @ wo

    def _B_ref(x, w1, b1, w2, b2):
        B, S, D = x.shape
        h = _layernorm(x, axis=-1)
        u = torch.einsum("bsd,sf->bdf", h, w1) + b1
        u = _gelu(u)
        y = torch.einsum("bdf,fs->bds", u, w2) + b2
        return (lambda x, *d: x.permute(*d))(y, 0, 2, 1)

    x = A_x
    xn = _layernorm(x, axis=-1)
    return x + _A_ref(xn, A_k_cache, A_v_cache, A_wq, A_wo) + _B_ref(xn, B_w1, B_b1, B_w2, B_b2)
```

```asm
; @launch grid=(256,1,1) block=(256,1,1) lds=4608
.amdgcn_target "amdgcn-amd-amdhsa--gfx950"
.text
.globl parallel_sum__mha_block_cached__mixer_token_mlp__decode_kernel
.p2align 8
.type parallel_sum__mha_block_cached__mixer_token_mlp__decode_kernel,@function
parallel_sum__mha_block_cached__mixer_token_mlp__decode_kernel:
    s_cmp_ge_u32 s2, 256
    s_cbranch_scc1 L_end
    s_load_dwordx16 s[4:19], s[0:1], 0
    s_load_dwordx8 s[20:27], s[0:1], 64
    s_load_dwordx2 s[28:29], s[0:1], 96
    v_lshrrev_b32 v7, 6, v0
    v_and_b32 v123, 15, v0
    v_readfirstlane_b32 s3, v7
    v_bfe_u32 v124, v0, 4, 2
    s_and_b32 s55, s2, 7
    s_lshl_b32 s55, s55, 2
    s_lshr_b32 s48, s2, 6
    s_or_b32 s48, s48, s55
    v_lshlrev_b32 v1, 6, v123
    v_lshl_or_b32 v1, v124, 4, v1
    s_bfe_u32 s51, s2, 0x10003
    s_lshl_b32 s51, s51, 15
    s_bfe_u32 s55, s2, 0x20004
    s_lshl_b32 s55, s55, 21
    s_or_b32 s51, s51, s55
    s_bfe_u32 s55, s3, 0x20000
    s_lshl_b32 s55, s55, 10
    s_or_b32 s51, s51, s55
    v_or_b32 v1, s51, v1
    s_lshl_b32 s55, s48, 23
    s_mov_b32 s34, 0x800000
    s_mov_b32 s35, 0x20000
    s_waitcnt lgkmcnt(0)
    s_add_u32 s32, s6, s55
    s_addc_u32 s33, s7, 0
    s_mov_b32 s52, 0x0
    buffer_load_dwordx4 a[0:3], v1, s[32:35], s52 offen offset:0 nt
    s_mov_b32 s52, 0x1000
    buffer_load_dwordx4 a[4:7], v1, s[32:35], s52 offen offset:0 nt
    s_mov_b32 s52, 0x2000
    buffer_load_dwordx4 a[8:11], v1, s[32:35], s52 offen offset:0 nt
    s_mov_b32 s52, 0x3000
    buffer_load_dwordx4 a[12:15], v1, s[32:35], s52 offen offset:0 nt
    s_mov_b32 s52, 0x4000
    buffer_load_dwordx4 a[16:19], v1, s[32:35], s52 offen offset:0 nt
    v_and_b32 v0, 63, v0
    s_bfe_u32 s49, s2, 0x30003
    s_lshl_b32 s56, s48, 8
    s_lshl_b32 s54, s48, 17
    s_add_u32 s36, s8, s55
    s_addc_u32 s37, s9, 0
    s_mov_b32 s38, 0x800000
    s_mov_b32 s39, 0x20000
    s_add_u32 s40, s10, s56
    s_addc_u32 s41, s11, 0
    s_mov_b32 s42, 0x3fe100
    s_mov_b32 s43, 0x20000
    s_add_u32 s44, s12, s54
    s_addc_u32 s45, s13, 0
    s_mov_b32 s46, 0x20000
    s_mov_b32 s47, 0x20000
    s_mul_i32 s53, s49, 131072
    s_lshr_b32 s55, s53, 15
    s_lshl_b32 s56, s3, 8
    v_xor_b32 v120, s55, v123
    v_xor_b32 v121, 16, v120
    v_lshlrev_b32 v120, 3, v120
    v_lshl_or_b32 v120, v124, 1, v120
    v_or_b32 v120, s56, v120
    v_lshlrev_b32 v121, 3, v121
    v_lshl_or_b32 v121, v124, 1, v121
    v_or_b32 v121, s56, v121
    v_lshlrev_b32 v4, 10, v124
    v_lshl_or_b32 v4, v123, 4, v4
    v_or_b32 v4, s56, v4
    s_lshl_b32 s50, s48, 3
    s_or_b32 s50, s50, s49
    s_lshl_b32 s55, s50, 1
    s_lshr_b32 s56, s3, 1
    s_add_u32 s55, s55, s56
    s_lshl_b32 s55, s55, 1
    v_mov_b32 v122, s55
    v_lshlrev_b32 v84, 4, v0
    v_or_b32 v2, s51, v84
    global_load_dwordx4 v[84:87], v84, s[4:5]
    global_load_ushort v120, v120, s[4:5]
    global_load_ushort v121, v121, s[4:5]
    global_load_ushort v122, v122, s[4:5]
    s_lshl_b32 s55, s3, 20
    v_lshlrev_b32 v3, 13, v124
    v_lshl_or_b32 v3, v123, 4, v3
    v_or_b32 v3, s55, v3
    s_lshl_b32 s56, s3, 9
    v_lshlrev_b32 v127, 5, v123
    v_lshl_or_b32 v127, v124, 3, v127
    v_or_b32 v127, s56, v127
    s_lshl_b32 s55, s50, 6
    s_lshl_b32 s56, s3, 17
    s_or_b32 s55, s55, s56
    v_and_b32 v126, 63, v127
    v_lshrrev_b32 v125, 1, v123
    v_lshl_or_b32 v126, v125, 14, v126
    v_or_b32 v126, s55, v126
    s_cmp_eq_u32 s3, 0
    s_cselect_b32 s58, s2, -1
    s_mov_b32 s30, 1
    v_and_b32 v7, 1, v0
    v_lshlrev_b32 v7, 4, v7
    v_mov_b32 v125, 0xffff
    v_lshlrev_b32 v7, v7, v125
    v_and_b32 v125, 2, v0
    v_cmp_eq_u32 vcc, 0, v125
    s_nop 1
    v_cndmask_b32 v5, 0, v7, vcc
    v_cndmask_b32 v6, v7, 0, vcc
    s_bfe_u32 s55, s2, 0x30003
    s_lshl_b32 s55, s55, 8
    s_add_u32 s55, s55, 0x84000
    s_add_u32 s60, s28, s55
    s_addc_u32 s61, s29, 0
    s_mov_b32 s63, 0
    v_mov_b32 v111, 4160
    s_xor_b32 s54, s53, 0x0
    buffer_load_dwordx4 a[20:23], v3, s[40:43], s54 offen
    s_waitcnt vmcnt(9)
    s_mov_b32 s52, 0x5000
    buffer_load_dwordx4 a[24:27], v1, s[32:35], s52 offen offset:0 nt
    s_waitcnt vmcnt(9)
    s_mov_b32 s52, 0x6000
    buffer_load_dwordx4 a[28:31], v1, s[32:35], s52 offen offset:0 nt
    s_waitcnt vmcnt(9)
    s_mov_b32 s52, 0x7000
    buffer_load_dwordx4 a[32:35], v1, s[32:35], s52 offen offset:0 nt
    s_xor_b32 s54, s53, 0x8000
    buffer_load_dwordx4 a[36:39], v3, s[40:43], s54 offen
    s_waitcnt vmcnt(10)
    s_mov_b32 s52, 0x10000
    buffer_load_dwordx4 a[40:43], v1, s[32:35], s52 offen offset:0 nt
    v_mov_b32 v40, -1
    v_mov_b32 v41, -1
    v_mov_b32 v42, -1
    v_mov_b32 v43, -1
    s_lshl_b32 s55, s2, 14
    s_waitcnt vmcnt(10)
    s_mov_b32 s52, 0x11000
    buffer_load_dwordx4 a[44:47], v1, s[32:35], s52 offen offset:0 nt
    s_xor_b32 s54, s53, 0x10000
    buffer_load_dwordx4 a[48:51], v3, s[40:43], s54 offen
    s_lshl_b32 s56, s3, 12
    s_or_b32 s55, s55, s56
    v_lshlrev_b32 v45, 4, v0
    v_or_b32 v44, s55, v45
    s_lshl_b32 s55, s2, 9
    s_waitcnt vmcnt(6)
    s_mov_b32 s52, 0x12000
    buffer_load_dwordx4 a[52:55], v1, s[32:35], s52 offen offset:0 nt
    v_lshlrev_b32 v88, 16, v84
    v_and_b32 v89, 0xffff0000, v84
    v_lshlrev_b32 v90, 16, v85
    v_and_b32 v91, 0xffff0000, v85
    v_lshlrev_b32 v92, 16, v86
    v_and_b32 v93, 0xffff0000, v86
    v_lshlrev_b32 v94, 16, v87
    v_and_b32 v95, 0xffff0000, v87
    v_lshlrev_b32 v120, 16, v120
    v_lshlrev_b32 v121, 16, v121
    v_lshlrev_b32 v122, 16, v122
    v_add_f32 v123, v88, v89
    v_add_f32 v7, v90, v91
    v_add_f32 v124, v92, v93
    v_add_f32 v125, v94, v95
    v_add_f32 v123, v123, v7
    v_add_f32 v124, v124, v125
    v_add_f32 v123, v123, v124
    s_nop 1
    v_add_f32_dpp v123, v123, v123 quad_perm:[1,0,3,2] row_mask:0xf bank_mask:0xf
    s_nop 1
    v_add_f32_dpp v123, v123, v123 quad_perm:[2,3,0,1] row_mask:0xf bank_mask:0xf
    s_nop 1
    v_add_f32_dpp v123, v123, v123 row_half_mirror row_mask:0xf bank_mask:0xf
    s_nop 1
    v_add_f32_dpp v123, v123, v123 row_mirror row_mask:0xf bank_mask:0xf
    v_mov_b32 v7, v123
    s_nop 1
    v_permlane16_swap_b32 v123, v7
    s_lshl_b32 s56, s3, 7
    s_or_b32 s55, s55, s56
    s_add_u32 s55, s55, 0x80000
    v_add_u32 v46, s55, v45
    s_lshl_b32 s55, s2, 10
    s_waitcnt vmcnt(6)
    s_mov_b32 s52, 0x13000
    buffer_load_dwordx4 a[56:59], v1, s[32:35], s52 offen offset:0 nt
    v_add_f32 v123, v123, v7
    v_mov_b32 v7, v123
    s_nop 1
    v_permlane32_swap_b32 v123, v7
    v_add_f32 v123, v123, v7
    v_mul_f32 v123, 0x3b000000, v123
    v_sub_f32 v7, v88, v123
    v_mul_f32 v124, v7, v7
    v_sub_f32 v7, v89, v123
    v_fmac_f32 v124, v7, v7
    v_sub_f32 v7, v90, v123
    v_fmac_f32 v124, v7, v7
    v_sub_f32 v7, v91, v123
    v_fmac_f32 v124, v7, v7
    v_sub_f32 v7, v92, v123
    v_fmac_f32 v124, v7, v7
    v_sub_f32 v7, v93, v123
    v_fmac_f32 v124, v7, v7
    v_sub_f32 v7, v94, v123
    v_fmac_f32 v124, v7, v7
    v_sub_f32 v7, v95, v123
    v_fmac_f32 v124, v7, v7
    s_nop 1
    v_add_f32_dpp v124, v124, v124 quad_perm:[1,0,3,2] row_mask:0xf bank_mask:0xf
    s_nop 1
    v_add_f32_dpp v124, v124, v124 quad_perm:[2,3,0,1] row_mask:0xf bank_mask:0xf
    s_nop 1
    v_add_f32_dpp v124, v124, v124 row_half_mirror row_mask:0xf bank_mask:0xf
    s_lshl_b32 s56, s3, 8
    s_or_b32 s55, s55, s56
    s_add_u32 s55, s55, 0x83f80
    v_add_u32 v45, s55, v45
    v_cmp_gt_u32 vcc, 8, v0
    s_nop 1
    v_cndmask_b32 v45, v45, v46, vcc
    s_waitcnt vmcnt(6)
    s_mov_b32 s52, 0x14000
    buffer_load_dwordx4 a[60:63], v1, s[32:35], s52 offen offset:0 nt
    s_xor_b32 s54, s53, 0x18000
    buffer_load_dwordx4 a[64:67], v3, s[40:43], s54 offen
    v_add_f32_dpp v124, v124, v124 row_mirror row_mask:0xf bank_mask:0xf
    v_mov_b32 v7, v124
    s_nop 1
    v_permlane16_swap_b32 v124, v7
    v_add_f32 v124, v124, v7
    v_mov_b32 v7, v124
    s_nop 1
    v_permlane32_swap_b32 v124, v7
    v_add_f32 v124, v124, v7
    v_mul_f32 v124, 0x3b000000, v124
    v_cvt_pk_bf16_f32 v7, v123, v124
    v_lshlrev_b32 v123, 16, v7
    v_and_b32 v124, 0xffff0000, v7
    v_add_f32 v124, 0x3727c5ac, v124
    v_cvt_pk_bf16_f32 v124, v124, v124
    v_and_b32 v124, 0xffff0000, v124
    v_sqrt_f32 v124, v124
    s_nop 0
    v_cvt_pk_bf16_f32 v124, v124, v124
    v_and_b32 v124, 0xffff0000, v124
    v_rcp_f32 v124, v124
    v_sub_f32 v120, v120, v123
    v_sub_f32 v121, v121, v123
    v_cvt_pk_bf16_f32 v7, v120, v121
    v_lshlrev_b32 v120, 16, v7
    v_and_b32 v121, 0xffff0000, v7
    v_mul_f32 v120, v120, v124
    s_cmp_lt_u32 s2, 32
    s_cbranch_scc0 L_skip1
    global_store_dwordx4 v44, v[40:43], s[28:29] offset:0 sc1
L_skip1:
    s_waitcnt vmcnt(6)
    s_mov_b32 s52, 0x15000
    buffer_load_dwordx4 a[68:71], v1, s[32:35], s52 offen offset:0 nt
    v_mul_f32 v121, v121, v124
    v_cvt_pk_bf16_f32 v7, v120, v121
    v_lshlrev_b32 v120, 16, v7
    v_and_b32 v121, 0xffff0000, v7
    v_cvt_pk_bf16_f32 v120, v120, v120
    s_nop 1
    v_and_b32_dpp v56, v120, v5 quad_perm:[0,0,0,0] row_mask:0xf bank_mask:0xf
    v_and_b32_dpp v57, v120, v6 quad_perm:[0,0,0,0] row_mask:0xf bank_mask:0xf
    v_and_b32_dpp v58, v120, v5 quad_perm:[1,1,1,1] row_mask:0xf bank_mask:0xf
    v_and_b32_dpp v59, v120, v6 quad_perm:[1,1,1,1] row_mask:0xf bank_mask:0xf
    v_and_b32_dpp v60, v120, v5 quad_perm:[2,2,2,2] row_mask:0xf bank_mask:0xf
    v_and_b32_dpp v61, v120, v6 quad_perm:[2,2,2,2] row_mask:0xf bank_mask:0xf
    v_and_b32_dpp v62, v120, v5 quad_perm:[3,3,3,3] row_mask:0xf bank_mask:0xf
    v_and_b32_dpp v63, v120, v6 quad_perm:[3,3,3,3] row_mask:0xf bank_mask:0xf
    v_cvt_pk_bf16_f32 v121, v121, v121
    s_nop 1
    v_and_b32_dpp v64, v121, v5 quad_perm:[0,0,0,0] row_mask:0xf bank_mask:0xf
    v_and_b32_dpp v65, v121, v6 quad_perm:[0,0,0,0] row_mask:0xf bank_mask:0xf
    v_and_b32_dpp v66, v121, v5 quad_perm:[1,1,1,1] row_mask:0xf bank_mask:0xf
    v_and_b32_dpp v67, v121, v6 quad_perm:[1,1,1,1] row_mask:0xf bank_mask:0xf
    v_and_b32_dpp v68, v121, v5 quad_perm:[2,2,2,2] row_mask:0xf bank_mask:0xf
    v_and_b32_dpp v69, v121, v6 quad_perm:[2,2,2,2] row_mask:0xf bank_mask:0xf
    v_and_b32_dpp v70, v121, v5 quad_perm:[3,3,3,3] row_mask:0xf bank_mask:0xf
    v_and_b32_dpp v71, v121, v6 quad_perm:[3,3,3,3] row_mask:0xf bank_mask:0xf
    v_sub_f32 v88, v88, v123
    v_sub_f32 v89, v89, v123
    s_waitcnt vmcnt(6)
    s_mov_b32 s52, 0x16000
    buffer_load_dwordx4 a[72:75], v1, s[32:35], s52 offen offset:0 nt
    s_xor_b32 s54, s53, 0x20000
    buffer_load_dwordx4 a[76:79], v3, s[40:43], s54 offen
    v_cvt_pk_bf16_f32 v7, v88, v89
    v_lshlrev_b32 v88, 16, v7
    v_and_b32 v89, 0xffff0000, v7
    v_mul_f32 v88, v88, v124
    v_mul_f32 v89, v89, v124
    v_cvt_pk_bf16_f32 v7, v88, v89
    v_lshlrev_b32 v88, 16, v7
    v_and_b32 v89, 0xffff0000, v7
    v_sub_f32 v90, v90, v123
    v_sub_f32 v91, v91, v123
    v_cvt_pk_bf16_f32 v7, v90, v91
    v_lshlrev_b32 v90, 16, v7
    v_and_b32 v91, 0xffff0000, v7
    v_mul_f32 v90, v90, v124
    v_mul_f32 v91, v91, v124
    v_cvt_pk_bf16_f32 v7, v90, v91
    v_lshlrev_b32 v90, 16, v7
    v_and_b32 v91, 0xffff0000, v7
    v_sub_f32 v92, v92, v123
    v_sub_f32 v93, v93, v123
    v_cvt_pk_bf16_f32 v7, v92, v93
    v_lshlrev_b32 v92, 16, v7
    v_and_b32 v93, 0xffff0000, v7
    v_mul_f32 v92, v92, v124
    s_waitcnt vmcnt(6)
    s_mov_b32 s52, 0x17000
    buffer_load_dwordx4 a[80:83], v1, s[32:35], s52 offen offset:0 nt
    v_mul_f32 v93, v93, v124
    v_cvt_pk_bf16_f32 v7, v92, v93
    v_lshlrev_b32 v92, 16, v7
    v_and_b32 v93, 0xffff0000, v7
    v_sub_f32 v94, v94, v123
    v_sub_f32 v95, v95, v123
    v_cvt_pk_bf16_f32 v7, v94, v95
    v_lshlrev_b32 v94, 16, v7
    v_and_b32 v95, 0xffff0000, v7
    v_mul_f32 v94, v94, v124
    v_mul_f32 v95, v95, v124
    v_cvt_pk_bf16_f32 v7, v94, v95
    v_lshlrev_b32 v94, 16, v7
    v_and_b32 v95, 0xffff0000, v7
    v_sub_f32 v122, v122, v123
    v_sub_f32 v120, v120, v123
    v_cvt_pk_bf16_f32 v7, v122, v120
    v_lshlrev_b32 v122, 16, v7
    v_and_b32 v120, 0xffff0000, v7
    v_mul_f32 v122, v122, v124
    v_mul_f32 v120, v120, v124
    v_cvt_pk_bf16_f32 v7, v122, v120
    v_lshlrev_b32 v122, 16, v7
    v_and_b32 v120, 0xffff0000, v7
    s_waitcnt vmcnt(6)
    s_mov_b32 s52, 0x20000
    buffer_load_dwordx4 a[84:87], v1, s[32:35], s52 offen offset:0 nt
    v_mfma_f32_4x4x4_16b_bf16 v[72:75], v[56:57], a[20:21], 0 cbsz:2 abid:0
    v_mfma_f32_4x4x4_16b_bf16 v[76:79], v[56:57], a[22:23], 0 cbsz:2 abid:0
    s_nop 0
    v_mfma_f32_4x4x4_16b_bf16 v[72:75], v[58:59], a[36:37], v[72:75] cbsz:2 abid:0
    v_mfma_f32_4x4x4_16b_bf16 v[76:79], v[58:59], a[38:39], v[76:79] cbsz:2 abid:0
    s_nop 0
    v_mfma_f32_4x4x4_16b_bf16 v[72:75], v[60:61], a[48:49], v[72:75] cbsz:2 abid:0
    v_mfma_f32_4x4x4_16b_bf16 v[76:79], v[60:61], a[50:51], v[76:79] cbsz:2 abid:0
    s_waitcnt vmcnt(6)
    s_mov_b32 s52, 0x21000
    buffer_load_dwordx4 a[88:91], v1, s[32:35], s52 offen offset:0 nt
    s_xor_b32 s54, s53, 0x28000
    buffer_load_dwordx4 a[92:95], v3, s[40:43], s54 offen
    s_waitcnt vmcnt(6)
    s_mov_b32 s52, 0x22000
    buffer_load_dwordx4 a[96:99], v1, s[32:35], s52 offen offset:0 nt
    v_mfma_f32_4x4x4_16b_bf16 v[72:75], v[62:63], a[64:65], v[72:75] cbsz:2 abid:0
    v_mfma_f32_4x4x4_16b_bf16 v[76:79], v[62:63], a[66:67], v[76:79] cbsz:2 abid:0
    s_waitcnt vmcnt(6)
    s_mov_b32 s52, 0x23000
    buffer_load_dwordx4 a[100:103], v1, s[32:35], s52 offen offset:0 nt
    s_xor_b32 s54, s53, 0x30000
    buffer_load_dwordx4 a[104:107], v3, s[40:43], s54 offen
    s_waitcnt vmcnt(6)
    s_mov_b32 s52, 0x24000
    buffer_load_dwordx4 a[108:111], v1, s[32:35], s52 offen offset:0 nt
    v_mfma_f32_4x4x4_16b_bf16 v[72:75], v[56:57], a[76:77], v[72:75] cbsz:2 abid:1
    v_mfma_f32_4x4x4_16b_bf16 v[76:79], v[56:57], a[78:79], v[76:79] cbsz:2 abid:1
    s_cmp_lt_u32 s2, 32
    s_cbranch_scc0 L_skip2
    global_store_dwordx4 v44, v[40:43], s[28:29] offset:1024 sc1
L_skip2:
    s_waitcnt vmcnt(6)
    s_mov_b32 s52, 0x25000
    buffer_load_dwordx4 a[112:115], v1, s[32:35], s52 offen offset:0 nt
    s_waitcnt vmcnt(6)
    s_mov_b32 s52, 0x26000
    buffer_load_dwordx4 a[116:119], v1, s[32:35], s52 offen offset:0 nt
    s_xor_b32 s54, s53, 0x38000
    buffer_load_dwordx4 a[120:123], v3, s[40:43], s54 offen
    s_waitcnt vmcnt(6)
    s_mov_b32 s52, 0x27000
    buffer_load_dwordx4 a[124:127], v1, s[32:35], s52 offen offset:0 nt
    v_mfma_f32_4x4x4_16b_bf16 v[72:75], v[58:59], a[92:93], v[72:75] cbsz:2 abid:1
    v_mfma_f32_4x4x4_16b_bf16 v[76:79], v[58:59], a[94:95], v[76:79] cbsz:2 abid:1
    s_waitcnt vmcnt(6)
    s_mov_b32 s52, 0x30000
    buffer_load_dwordx4 a[128:131], v1, s[32:35], s52 offen offset:0 nt
    s_xor_b32 s54, s53, 0x40000
    buffer_load_dwordx4 a[132:135], v3, s[40:43], s54 offen
    s_waitcnt vmcnt(6)
    s_mov_b32 s52, 0x31000
    buffer_load_dwordx4 a[136:139], v1, s[32:35], s52 offen offset:0 nt
    v_mfma_f32_4x4x4_16b_bf16 v[72:75], v[60:61], a[104:105], v[72:75] cbsz:2 abid:1
    v_mfma_f32_4x4x4_16b_bf16 v[76:79], v[60:61], a[106:107], v[76:79] cbsz:2 abid:1
    s_waitcnt vmcnt(6)
    s_mov_b32 s52, 0x32000
    buffer_load_dwordx4 a[140:143], v1, s[32:35], s52 offen offset:0 nt
    s_waitcnt vmcnt(6)
    s_mov_b32 s52, 0x33000
    buffer_load_dwordx4 a[144:147], v1, s[32:35], s52 offen offset:0 nt
    s_xor_b32 s54, s53, 0x48000
    buffer_load_dwordx4 a[148:151], v3, s[40:43], s54 offen
    s_waitcnt vmcnt(6)
    s_mov_b32 s52, 0x34000
    buffer_load_dwordx4 a[152:155], v1, s[32:35], s52 offen offset:0 nt
    v_mfma_f32_4x4x4_16b_bf16 v[72:75], v[62:63], a[120:121], v[72:75] cbsz:2 abid:1
    v_mfma_f32_4x4x4_16b_bf16 v[76:79], v[62:63], a[122:123], v[76:79] cbsz:2 abid:1
    s_cmp_lt_u32 s2, 32
    s_cbranch_scc0 L_skip3
    global_store_dwordx4 v44, v[40:43], s[28:29] offset:2048 sc1
L_skip3:
    s_waitcnt vmcnt(6)
    s_mov_b32 s52, 0x35000
    buffer_load_dwordx4 a[156:159], v1, s[32:35], s52 offen offset:0 nt
    s_xor_b32 s54, s53, 0x50000
    buffer_load_dwordx4 a[160:163], v3, s[40:43], s54 offen
    s_waitcnt vmcnt(6)
    s_mov_b32 s52, 0x36000
    buffer_load_dwordx4 a[164:167], v1, s[32:35], s52 offen offset:0 nt
    v_mfma_f32_4x4x4_16b_bf16 v[72:75], v[56:57], a[132:133], v[72:75] cbsz:2 abid:2
    v_mfma_f32_4x4x4_16b_bf16 v[76:79], v[56:57], a[134:135], v[76:79] cbsz:2 abid:2
    s_waitcnt vmcnt(6)
    s_mov_b32 s52, 0x37000
    buffer_load_dwordx4 a[168:171], v1, s[32:35], s52 offen offset:0 nt
    s_waitcnt vmcnt(6)
    s_mov_b32 s52, 0x40000
    buffer_load_dwordx4 a[172:175], v1, s[32:35], s52 offen offset:0 nt
    s_xor_b32 s54, s53, 0x58000
    buffer_load_dwordx4 a[176:179], v3, s[40:43], s54 offen
    s_waitcnt vmcnt(6)
    s_mov_b32 s52, 0x41000
    buffer_load_dwordx4 a[180:183], v1, s[32:35], s52 offen offset:0 nt
    v_mfma_f32_4x4x4_16b_bf16 v[72:75], v[58:59], a[148:149], v[72:75] cbsz:2 abid:2
    v_mfma_f32_4x4x4_16b_bf16 v[76:79], v[58:59], a[150:151], v[76:79] cbsz:2 abid:2
    s_waitcnt vmcnt(6)
    s_mov_b32 s52, 0x42000
    buffer_load_dwordx4 a[184:187], v1, s[32:35], s52 offen offset:0 nt
    s_xor_b32 s54, s53, 0x60000
    buffer_load_dwordx4 a[188:191], v3, s[40:43], s54 offen
    s_waitcnt vmcnt(6)
    s_mov_b32 s52, 0x43000
    buffer_load_dwordx4 a[192:195], v1, s[32:35], s52 offen offset:0 nt
    v_mfma_f32_4x4x4_16b_bf16 v[72:75], v[60:61], a[160:161], v[72:75] cbsz:2 abid:2
    v_mfma_f32_4x4x4_16b_bf16 v[76:79], v[60:61], a[162:163], v[76:79] cbsz:2 abid:2
    s_waitcnt vmcnt(6)
    s_mov_b32 s52, 0x44000
    buffer_load_dwordx4 a[196:199], v1, s[32:35], s52 offen offset:0 nt
    s_cmp_lt_u32 s2, 32
    s_cbranch_scc0 L_skip4
    global_store_dwordx4 v44, v[40:43], s[28:29] offset:3072 sc1
L_skip4:
    s_waitcnt vmcnt(6)
    s_mov_b32 s52, 0x45000
    buffer_load_dwordx4 a[200:203], v1, s[32:35], s52 offen offset:0 nt
    s_xor_b32 s54, s53, 0x68000
    buffer_load_dwordx4 a[204:207], v3, s[40:43], s54 offen
    s_waitcnt vmcnt(6)
    s_mov_b32 s52, 0x46000
    buffer_load_dwordx4 a[208:211], v1, s[32:35], s52 offen offset:0 nt
    v_mfma_f32_4x4x4_16b_bf16 v[72:75], v[62:63], a[176:177], v[72:75] cbsz:2 abid:2
    v_mfma_f32_4x4x4_16b_bf16 v[76:79], v[62:63], a[178:179], v[76:79] cbsz:2 abid:2
    s_waitcnt vmcnt(6)
    s_mov_b32 s52, 0x47000
    buffer_load_dwordx4 a[212:215], v1, s[32:35], s52 offen offset:0 nt
    s_xor_b32 s54, s53, 0x70000
    buffer_load_dwordx4 a[216:219], v3, s[40:43], s54 offen
    s_waitcnt vmcnt(6)
    s_mov_b32 s52, 0x50000
    buffer_load_dwordx4 a[220:223], v1, s[32:35], s52 offen offset:0 nt
    v_mfma_f32_4x4x4_16b_bf16 v[72:75], v[56:57], a[188:189], v[72:75] cbsz:2 abid:3
    v_mfma_f32_4x4x4_16b_bf16 v[76:79], v[56:57], a[190:191], v[76:79] cbsz:2 abid:3
    s_waitcnt vmcnt(6)
    s_mov_b32 s52, 0x51000
    buffer_load_dwordx4 a[224:227], v1, s[32:35], s52 offen offset:0 nt
    s_waitcnt vmcnt(6)
    s_mov_b32 s52, 0x52000
    buffer_load_dwordx4 a[228:231], v1, s[32:35], s52 offen offset:0 nt
    s_xor_b32 s54, s53, 0x78000
    buffer_load_dwordx4 a[232:235], v3, s[40:43], s54 offen
    s_waitcnt vmcnt(6)
    s_mov_b32 s52, 0x53000
    buffer_load_dwordx4 a[236:239], v1, s[32:35], s52 offen offset:0 nt
    v_mfma_f32_4x4x4_16b_bf16 v[72:75], v[58:59], a[204:205], v[72:75] cbsz:2 abid:3
    v_mfma_f32_4x4x4_16b_bf16 v[76:79], v[58:59], a[206:207], v[76:79] cbsz:2 abid:3
    s_waitcnt vmcnt(6)
    s_mov_b32 s52, 0x54000
    buffer_load_dwordx4 a[240:243], v1, s[32:35], s52 offen offset:0 nt
    s_xor_b32 s54, s53, 0x80000
    buffer_load_dwordx4 a[244:247], v3, s[40:43], s54 offen
    s_cmp_lt_u32 s2, 32
    s_cbranch_scc0 L_skip5
    s_mov_b64 exec, 0xfff
    global_store_dwordx4 v45, v[40:43], s[28:29] sc1
    s_mov_b64 exec, -1
L_skip5:
    s_waitcnt vmcnt(6)
    s_mov_b32 s52, 0x55000
    buffer_load_dwordx4 a[248:251], v1, s[32:35], s52 offen offset:0 nt
    v_mfma_f32_4x4x4_16b_bf16 v[72:75], v[60:61], a[216:217], v[72:75] cbsz:2 abid:3
    v_mfma_f32_4x4x4_16b_bf16 v[76:79], v[60:61], a[218:219], v[76:79] cbsz:2 abid:3
    s_waitcnt vmcnt(6)
    s_mov_b32 s52, 0x56000
    buffer_load_dwordx4 a[252:255], v1, s[32:35], s52 offen offset:0 nt
    s_waitcnt vmcnt(6)
    s_mov_b32 s52, 0x57000
    buffer_load_dwordx4 v[128:131], v1, s[32:35], s52 offen offset:0 nt
    s_xor_b32 s54, s53, 0x88000
    buffer_load_dwordx4 v[132:135], v3, s[40:43], s54 offen
    s_waitcnt vmcnt(6)
    s_mov_b32 s52, 0x60000
    buffer_load_dwordx4 v[136:139], v1, s[32:35], s52 offen offset:0 nt
    v_mfma_f32_4x4x4_16b_bf16 v[72:75], v[62:63], a[232:233], v[72:75] cbsz:2 abid:3
    v_mfma_f32_4x4x4_16b_bf16 v[76:79], v[62:63], a[234:235], v[76:79] cbsz:2 abid:3
    s_waitcnt vmcnt(6)
    s_mov_b32 s52, 0x61000
    buffer_load_dwordx4 v[140:143], v1, s[32:35], s52 offen offset:0 nt
    s_xor_b32 s54, s53, 0x90000
    buffer_load_dwordx4 v[144:147], v3, s[40:43], s54 offen
    s_waitcnt vmcnt(6)
    s_mov_b32 s52, 0x62000
    buffer_load_dwordx4 v[148:151], v1, s[32:35], s52 offen offset:0 nt
    v_mfma_f32_4x4x4_16b_bf16 v[72:75], v[64:65], a[244:245], v[72:75] cbsz:2 abid:0
    v_mfma_f32_4x4x4_16b_bf16 v[76:79], v[64:65], a[246:247], v[76:79] cbsz:2 abid:0
    s_waitcnt vmcnt(6)
    s_mov_b32 s52, 0x63000
    buffer_load_dwordx4 v[152:155], v1, s[32:35], s52 offen offset:0 nt
    s_waitcnt vmcnt(6)
    s_mov_b32 s52, 0x64000
    buffer_load_dwordx4 v[156:159], v1, s[32:35], s52 offen offset:0 nt
    s_xor_b32 s54, s53, 0x98000
    buffer_load_dwordx4 v[160:163], v3, s[40:43], s54 offen
    s_waitcnt vmcnt(6)
    s_mov_b32 s52, 0x65000
    buffer_load_dwordx4 v[164:167], v1, s[32:35], s52 offen offset:0 nt
    v_mfma_f32_4x4x4_16b_bf16 v[72:75], v[66:67], v[132:133], v[72:75] cbsz:2 abid:0
    v_mfma_f32_4x4x4_16b_bf16 v[76:79], v[66:67], v[134:135], v[76:79] cbsz:2 abid:0
    s_waitcnt vmcnt(6)
    s_mov_b32 s52, 0x66000
    buffer_load_dwordx4 v[168:171], v1, s[32:35], s52 offen offset:0 nt
    s_xor_b32 s54, s53, 0xa0000
    buffer_load_dwordx4 v[172:175], v3, s[40:43], s54 offen
    s_waitcnt vmcnt(6)
    s_mov_b32 s52, 0x67000
    buffer_load_dwordx4 v[176:179], v1, s[32:35], s52 offen offset:0 nt
    v_mfma_f32_4x4x4_16b_bf16 v[72:75], v[68:69], v[144:145], v[72:75] cbsz:2 abid:0
    v_mfma_f32_4x4x4_16b_bf16 v[76:79], v[68:69], v[146:147], v[76:79] cbsz:2 abid:0
    s_waitcnt vmcnt(6)
    s_mov_b32 s52, 0x70000
    buffer_load_dwordx4 v[180:183], v1, s[32:35], s52 offen offset:0 nt
    s_waitcnt vmcnt(6)
    s_mov_b32 s52, 0x71000
    buffer_load_dwordx4 v[184:187], v1, s[32:35], s52 offen offset:0 nt
    s_xor_b32 s54, s53, 0xa8000
    buffer_load_dwordx4 v[188:191], v3, s[40:43], s54 offen
    s_waitcnt vmcnt(6)
    s_mov_b32 s52, 0x72000
    buffer_load_dwordx4 v[192:195], v1, s[32:35], s52 offen offset:0 nt
    v_mfma_f32_4x4x4_16b_bf16 v[72:75], v[70:71], v[160:161], v[72:75] cbsz:2 abid:0
    v_mfma_f32_4x4x4_16b_bf16 v[76:79], v[70:71], v[162:163], v[76:79] cbsz:2 abid:0
    s_waitcnt vmcnt(6)
    s_mov_b32 s52, 0x73000
    buffer_load_dwordx4 v[196:199], v1, s[32:35], s52 offen offset:0 nt
    s_xor_b32 s54, s53, 0xb0000
    buffer_load_dwordx4 v[200:203], v3, s[40:43], s54 offen
    s_waitcnt vmcnt(6)
    s_mov_b32 s52, 0x74000
    buffer_load_dwordx4 v[204:207], v1, s[32:35], s52 offen offset:0 nt
    v_mfma_f32_4x4x4_16b_bf16 v[72:75], v[64:65], v[172:173], v[72:75] cbsz:2 abid:1
    v_mfma_f32_4x4x4_16b_bf16 v[76:79], v[64:65], v[174:175], v[76:79] cbsz:2 abid:1
    s_waitcnt vmcnt(6)
    s_mov_b32 s52, 0x75000
    buffer_load_dwordx4 v[208:211], v1, s[32:35], s52 offen offset:0 nt
    s_waitcnt vmcnt(6)
    s_mov_b32 s52, 0x76000
    buffer_load_dwordx4 v[212:215], v1, s[32:35], s52 offen offset:0 nt
    s_xor_b32 s54, s53, 0xb8000
    buffer_load_dwordx4 v[216:219], v3, s[40:43], s54 offen
    s_waitcnt vmcnt(6)
    s_mov_b32 s52, 0x77000
    buffer_load_dwordx4 v[220:223], v1, s[32:35], s52 offen offset:0 nt
    v_mfma_f32_4x4x4_16b_bf16 v[72:75], v[66:67], v[188:189], v[72:75] cbsz:2 abid:1
    v_mfma_f32_4x4x4_16b_bf16 v[76:79], v[66:67], v[190:191], v[76:79] cbsz:2 abid:1
    s_waitcnt vmcnt(6)
    s_mov_b32 s52, 0x80000
    buffer_load_dwordx4 v[224:227], v1, s[32:35], s52 offen offset:0 nt
    s_xor_b32 s54, s53, 0xc0000
    buffer_load_dwordx4 v[228:231], v3, s[40:43], s54 offen
    s_waitcnt vmcnt(6)
    s_mov_b32 s52, 0x81000
    buffer_load_dwordx4 v[232:235], v1, s[32:35], s52 offen offset:0 nt
    v_mfma_f32_4x4x4_16b_bf16 v[72:75], v[68:69], v[200:201], v[72:75] cbsz:2 abid:1
    v_mfma_f32_4x4x4_16b_bf16 v[76:79], v[68:69], v[202:203], v[76:79] cbsz:2 abid:1
    s_waitcnt vmcnt(6)
    s_mov_b32 s52, 0x82000
    buffer_load_dwordx4 v[236:239], v1, s[32:35], s52 offen offset:0 nt
    s_waitcnt vmcnt(6)
    s_mov_b32 s52, 0x83000
    buffer_load_dwordx4 v[240:243], v1, s[32:35], s52 offen offset:0 nt
    s_xor_b32 s54, s53, 0xc8000
    buffer_load_dwordx4 v[244:247], v3, s[40:43], s54 offen
    s_waitcnt vmcnt(6)
    s_mov_b32 s52, 0x84000
    buffer_load_dwordx4 v[248:251], v1, s[32:35], s52 offen offset:0 nt
    v_mfma_f32_4x4x4_16b_bf16 v[72:75], v[70:71], v[216:217], v[72:75] cbsz:2 abid:1
    v_mfma_f32_4x4x4_16b_bf16 v[76:79], v[70:71], v[218:219], v[76:79] cbsz:2 abid:1
    s_waitcnt vmcnt(6)
    s_mov_b32 s52, 0x85000
    buffer_load_dwordx4 v[252:255], v1, s[32:35], s52 offen offset:0 nt
    s_xor_b32 s54, s53, 0xd0000
    buffer_load_dwordx4 a[20:23], v3, s[40:43], s54 offen
    s_waitcnt vmcnt(6)
    s_mov_b32 s52, 0x86000
    buffer_load_dwordx4 a[36:39], v1, s[32:35], s52 offen offset:0 nt
    v_mfma_f32_4x4x4_16b_bf16 v[72:75], v[64:65], v[228:229], v[72:75] cbsz:2 abid:2
    v_mfma_f32_4x4x4_16b_bf16 v[76:79], v[64:65], v[230:231], v[76:79] cbsz:2 abid:2
    s_waitcnt vmcnt(6)
    s_mov_b32 s52, 0x87000
    buffer_load_dwordx4 a[48:51], v1, s[32:35], s52 offen offset:0 nt
    s_waitcnt vmcnt(6)
    s_mov_b32 s52, 0x90000
    buffer_load_dwordx4 a[64:67], v1, s[32:35], s52 offen offset:0 nt
    s_xor_b32 s54, s53, 0xd8000
    buffer_load_dwordx4 a[76:79], v3, s[40:43], s54 offen
    s_waitcnt vmcnt(6)
    s_mov_b32 s52, 0x91000
    buffer_load_dwordx4 a[92:95], v1, s[32:35], s52 offen offset:0 nt
    v_mfma_f32_4x4x4_16b_bf16 v[72:75], v[66:67], v[244:245], v[72:75] cbsz:2 abid:2
    v_mfma_f32_4x4x4_16b_bf16 v[76:79], v[66:67], v[246:247], v[76:79] cbsz:2 abid:2
    s_waitcnt vmcnt(6)
    s_mov_b32 s52, 0x92000
    buffer_load_dwordx4 a[104:107], v1, s[32:35], s52 offen offset:0 nt
    s_xor_b32 s54, s53, 0xe0000
    buffer_load_dwordx4 a[120:123], v3, s[40:43], s54 offen
    s_waitcnt vmcnt(6)
    s_mov_b32 s52, 0x93000
    buffer_load_dwordx4 a[132:135], v1, s[32:35], s52 offen offset:0 nt
    v_mfma_f32_4x4x4_16b_bf16 v[72:75], v[68:69], a[20:21], v[72:75] cbsz:2 abid:2
    v_mfma_f32_4x4x4_16b_bf16 v[76:79], v[68:69], a[22:23], v[76:79] cbsz:2 abid:2
    s_waitcnt vmcnt(6)
    s_mov_b32 s52, 0x94000
    buffer_load_dwordx4 a[148:151], v1, s[32:35], s52 offen offset:0 nt
    s_waitcnt vmcnt(6)
    s_mov_b32 s52, 0x95000
    buffer_load_dwordx4 a[160:163], v1, s[32:35], s52 offen offset:0 nt
    s_xor_b32 s54, s53, 0xe8000
    buffer_load_dwordx4 a[176:179], v3, s[40:43], s54 offen
    s_waitcnt vmcnt(6)
    s_mov_b32 s52, 0x96000
    buffer_load_dwordx4 a[188:191], v1, s[32:35], s52 offen offset:0 nt
    v_mfma_f32_4x4x4_16b_bf16 v[72:75], v[70:71], a[76:77], v[72:75] cbsz:2 abid:2
    v_mfma_f32_4x4x4_16b_bf16 v[76:79], v[70:71], a[78:79], v[76:79] cbsz:2 abid:2
    s_waitcnt vmcnt(6)
    s_mov_b32 s52, 0x97000
    buffer_load_dwordx4 a[204:207], v1, s[32:35], s52 offen offset:0 nt
    s_xor_b32 s54, s53, 0xf0000
    buffer_load_dwordx4 a[216:219], v3, s[40:43], s54 offen
    s_waitcnt vmcnt(6)
    s_mov_b32 s52, 0xa0000
    buffer_load_dwordx4 a[232:235], v1, s[32:35], s52 offen offset:0 nt
    v_mfma_f32_4x4x4_16b_bf16 v[72:75], v[64:65], a[120:121], v[72:75] cbsz:2 abid:3
    v_mfma_f32_4x4x4_16b_bf16 v[76:79], v[64:65], a[122:123], v[76:79] cbsz:2 abid:3
    s_waitcnt vmcnt(6)
    s_mov_b32 s52, 0xa1000
    buffer_load_dwordx4 a[244:247], v1, s[32:35], s52 offen offset:0 nt
    s_waitcnt vmcnt(6)
    s_mov_b32 s52, 0xa2000
    buffer_load_dwordx4 v[132:135], v1, s[32:35], s52 offen offset:0 nt
    s_xor_b32 s54, s53, 0xf8000
    buffer_load_dwordx4 v[144:147], v3, s[40:43], s54 offen
    s_waitcnt vmcnt(6)
    s_mov_b32 s52, 0xa3000
    buffer_load_dwordx4 v[160:163], v1, s[32:35], s52 offen offset:0 nt
    v_mfma_f32_4x4x4_16b_bf16 v[72:75], v[66:67], a[176:177], v[72:75] cbsz:2 abid:3
    v_mfma_f32_4x4x4_16b_bf16 v[76:79], v[66:67], a[178:179], v[76:79] cbsz:2 abid:3
    s_waitcnt vmcnt(6)
    s_mov_b32 s52, 0xa4000
    buffer_load_dwordx4 v[172:175], v1, s[32:35], s52 offen offset:0 nt
    s_waitcnt vmcnt(5)
    s_mov_b32 s52, 0xa5000
    buffer_load_dwordx4 v[188:191], v1, s[32:35], s52 offen offset:0 nt
    v_mfma_f32_4x4x4_16b_bf16 v[72:75], v[68:69], a[216:217], v[72:75] cbsz:2 abid:3
    v_mfma_f32_4x4x4_16b_bf16 v[76:79], v[68:69], a[218:219], v[76:79] cbsz:2 abid:3
    s_waitcnt vmcnt(5)
    s_mov_b32 s52, 0xa6000
    buffer_load_dwordx4 v[200:203], v1, s[32:35], s52 offen offset:0 nt
    s_waitcnt vmcnt(5)
    s_mov_b32 s52, 0xa7000
    buffer_load_dwordx4 v[216:219], v1, s[32:35], s52 offen offset:0 nt
    s_waitcnt vmcnt(4)
    s_mov_b32 s52, 0xb0000
    buffer_load_dwordx4 v[228:231], v1, s[32:35], s52 offen offset:0 nt
    v_mfma_f32_4x4x4_16b_bf16 v[72:75], v[70:71], v[144:145], v[72:75] cbsz:2 abid:3
    v_mfma_f32_4x4x4_16b_bf16 v[76:79], v[70:71], v[146:147], v[76:79] cbsz:2 abid:3
    s_nop 4
    v_permlane32_swap_b32 v72, v76
    v_permlane32_swap_b32 v73, v77
    v_permlane32_swap_b32 v74, v78
    v_permlane32_swap_b32 v75, v79
    v_add_f32 v72, v72, v76
    v_add_f32 v73, v73, v77
    v_add_f32 v74, v74, v78
    v_add_f32 v75, v75, v79
    s_nop 0
    v_permlane16_swap_b32 v72, v74
    v_permlane16_swap_b32 v73, v75
    v_add_f32 v72, v72, v74
    v_add_f32 v73, v73, v75
    ds_write_b64 v127, v[72:73] offset:0
    v_bfe_u32 v123, v0, 2, 2
    v_lshrrev_b32 v124, 4, v0
    v_lshlrev_b32 v123, 7, v123
    v_lshl_or_b32 v123, v124, 5, v123
    s_waitcnt lgkmcnt(0)
    s_barrier
    ds_read_b128 v[24:27], v123 offset:0
    ds_read_b128 v[28:31], v123 offset:16
    ds_read_b128 v[32:35], v123 offset:512
    ds_read_b128 v[36:39], v123 offset:528
    s_waitcnt vmcnt(4)
    s_mov_b32 s52, 0xb1000
    buffer_load_dwordx4 v[244:247], v1, s[32:35], s52 offen offset:0 nt
    ds_read_b128 v[40:43], v123 offset:1024
    ds_read_b128 v[44:47], v123 offset:1040
    ds_read_b128 v[48:51], v123 offset:1536
    ds_read_b128 v[52:55], v123 offset:1552
    s_waitcnt lgkmcnt(4)
    v_add_f32 v24, v24, v32
    v_add_f32 v25, v25, v33
    v_add_f32 v26, v26, v34
    v_add_f32 v27, v27, v35
    v_add_f32 v28, v28, v36
    v_add_f32 v29, v29, v37
    v_add_f32 v30, v30, v38
    v_add_f32 v31, v31, v39
    s_waitcnt lgkmcnt(0)
    v_add_f32 v40, v40, v48
    v_add_f32 v41, v41, v49
    v_add_f32 v42, v42, v50
    v_add_f32 v43, v43, v51
    v_add_f32 v44, v44, v52
    v_add_f32 v45, v45, v53
    v_add_f32 v46, v46, v54
    v_add_f32 v47, v47, v55
    v_add_f32 v24, v24, v40
    v_add_f32 v25, v25, v41
    v_add_f32 v26, v26, v42
    v_add_f32 v27, v27, v43
    s_waitcnt vmcnt(4)
    s_mov_b32 s52, 0xb2000
    buffer_load_dwordx4 a[20:23], v1, s[32:35], s52 offen offset:0 nt
    v_add_f32 v28, v28, v44
    v_add_f32 v29, v29, v45
    v_add_f32 v30, v30, v46
    v_add_f32 v31, v31, v47
    v_cvt_pk_bf16_f32 v32, v24, v25
    v_cvt_pk_bf16_f32 v33, v26, v27
    v_cvt_pk_bf16_f32 v34, v28, v29
    v_cvt_pk_bf16_f32 v35, v30, v31
    v_and_b32 v7, 3, v0
    v_cmp_eq_u32 vcc, 0, v7
    s_nop 1
    v_cndmask_b32 v8, 0, v32, vcc
    v_cndmask_b32 v9, 0, v33, vcc
    v_cndmask_b32 v10, 0, v34, vcc
    v_cndmask_b32 v11, 0, v35, vcc
    v_cmp_eq_u32 vcc, 1, v7
    s_nop 1
    v_cndmask_b32 v12, 0, v32, vcc
    v_cndmask_b32 v13, 0, v33, vcc
    v_cndmask_b32 v14, 0, v34, vcc
    v_cndmask_b32 v15, 0, v35, vcc
    v_cmp_eq_u32 vcc, 2, v7
    s_nop 1
    v_cndmask_b32 v16, 0, v32, vcc
    v_cndmask_b32 v17, 0, v33, vcc
    v_cndmask_b32 v18, 0, v34, vcc
    v_cndmask_b32 v19, 0, v35, vcc
    s_waitcnt vmcnt(4)
    s_mov_b32 s52, 0xb3000
    buffer_load_dwordx4 a[76:79], v1, s[32:35], s52 offen offset:0 nt
    v_cmp_eq_u32 vcc, 3, v7
    s_nop 1
    v_cndmask_b32 v20, 0, v32, vcc
    v_cndmask_b32 v21, 0, v33, vcc
    v_cndmask_b32 v22, 0, v34, vcc
    v_cndmask_b32 v23, 0, v35, vcc
    v_mfma_f32_16x16x32_bf16 v[24:27], a[0:3], v[8:11], 0
    v_mfma_f32_16x16x32_bf16 v[24:27], a[4:7], v[12:15], v[24:27]
    v_mfma_f32_16x16x32_bf16 v[24:27], a[8:11], v[16:19], v[24:27]
    v_mfma_f32_16x16x32_bf16 v[24:27], a[12:15], v[20:23], v[24:27]
    v_mfma_f32_16x16x32_bf16 v[28:31], a[16:19], v[8:11], 0
    v_mfma_f32_16x16x32_bf16 v[28:31], a[24:27], v[12:15], v[28:31]
    v_mfma_f32_16x16x32_bf16 v[28:31], a[28:31], v[16:19], v[28:31]
    s_nop 4
    v_mov_b32_dpp v82, v24 quad_perm:[0,1,2,3] row_mask:0xf bank_mask:0x1
    v_mfma_f32_16x16x32_bf16 v[28:31], a[32:35], v[20:23], v[28:31]
    s_nop 0
    v_add_f32_dpp v82, v25, v82 row_ror:12 row_mask:0xf bank_mask:0x1
    v_mfma_f32_16x16x32_bf16 v[32:35], a[40:43], v[8:11], 0
    s_nop 0
    v_add_f32_dpp v82, v26, v82 row_ror:8 row_mask:0xf bank_mask:0x1
    v_mfma_f32_16x16x32_bf16 v[32:35], a[44:47], v[12:15], v[32:35]
    s_nop 0
    v_add_f32_dpp v82, v27, v82 row_ror:4 row_mask:0xf bank_mask:0x1
    v_mfma_f32_16x16x32_bf16 v[32:35], a[52:55], v[16:19], v[32:35]
    s_nop 0
    v_mov_b32_dpp v82, v28 row_ror:4 row_mask:0xf bank_mask:0x2
    v_mfma_f32_16x16x32_bf16 v[32:35], a[56:59], v[20:23], v[32:35]
    s_nop 0
    v_add_f32_dpp v82, v29, v82 quad_perm:[0,1,2,3] row_mask:0xf bank_mask:0x2
    s_waitcnt vmcnt(4)
    s_mov_b32 s52, 0xb4000
    buffer_load_dwordx4 a[120:123], v1, s[32:35], s52 offen offset:0 nt
    s_cmp_eq_u32 s58, 0
    s_cbranch_scc0 L_skip6
    s_atomic_add s30, s[26:27], 0
L_skip6:
    v_mfma_f32_16x16x32_bf16 v[36:39], a[60:63], v[8:11], 0
    v_add_f32_dpp v82, v30, v82 row_ror:12 row_mask:0xf bank_mask:0x2
    v_mfma_f32_16x16x32_bf16 v[36:39], a[68:71], v[12:15], v[36:39]
    s_nop 0
    v_add_f32_dpp v82, v31, v82 row_ror:8 row_mask:0xf bank_mask:0x2
    v_mfma_f32_16x16x32_bf16 v[36:39], a[72:75], v[16:19], v[36:39]
    s_nop 0
    v_mov_b32_dpp v82, v32 row_ror:8 row_mask:0xf bank_mask:0x4
    v_mfma_f32_16x16x32_bf16 v[36:39], a[80:83], v[20:23], v[36:39]
    s_nop 0
    v_add_f32_dpp v82, v33, v82 row_ror:4 row_mask:0xf bank_mask:0x4
    v_mfma_f32_16x16x32_bf16 v[24:27], a[84:87], v[8:11], 0
    s_nop 0
    v_add_f32_dpp v82, v34, v82 quad_perm:[0,1,2,3] row_mask:0xf bank_mask:0x4
    v_mfma_f32_16x16x32_bf16 v[24:27], a[88:91], v[12:15], v[24:27]
    s_nop 0
    v_add_f32_dpp v82, v35, v82 row_ror:12 row_mask:0xf bank_mask:0x4
    v_mfma_f32_16x16x32_bf16 v[24:27], a[96:99], v[16:19], v[24:27]
    s_nop 0
    v_mov_b32_dpp v82, v36 row_ror:12 row_mask:0xf bank_mask:0x8
    v_mfma_f32_16x16x32_bf16 v[24:27], a[100:103], v[20:23], v[24:27]
    s_nop 0
    v_add_f32_dpp v82, v37, v82 row_ror:8 row_mask:0xf bank_mask:0x8
    v_mfma_f32_16x16x32_bf16 v[28:31], a[108:111], v[8:11], 0
    s_nop 0
    v_add_f32_dpp v82, v38, v82 row_ror:4 row_mask:0xf bank_mask:0x8
    v_mfma_f32_16x16x32_bf16 v[28:31], a[112:115], v[12:15], v[28:31]
    s_nop 0
    v_add_f32_dpp v82, v39, v82 quad_perm:[0,1,2,3] row_mask:0xf bank_mask:0x8
    v_cvt_pk_bf16_f32 v40, v82, v82
    v_and_b32 v40, 0xffff0000, v40
    v_mul_f32 v40, 0x3db504f3, v40
    v_cvt_pk_bf16_f32 v40, v40, v40
    s_waitcnt vmcnt(4)
    s_mov_b32 s52, 0xb5000
    buffer_load_dwordx4 a[176:179], v1, s[32:35], s52 offen offset:0 nt
    v_and_b32 v40, 0xffff0000, v40
    v_mov_b32 v80, v40
    v_mfma_f32_16x16x32_bf16 v[28:31], a[116:119], v[16:19], v[28:31]
    v_mov_b32_dpp v83, v24 quad_perm:[0,1,2,3] row_mask:0xf bank_mask:0x1
    v_mfma_f32_16x16x32_bf16 v[28:31], a[124:127], v[20:23], v[28:31]
    s_nop 0
    v_add_f32_dpp v83, v25, v83 row_ror:12 row_mask:0xf bank_mask:0x1
    v_mfma_f32_16x16x32_bf16 v[32:35], a[128:131], v[8:11], 0
    s_nop 0
    v_add_f32_dpp v83, v26, v83 row_ror:8 row_mask:0xf bank_mask:0x1
    v_mfma_f32_16x16x32_bf16 v[32:35], a[136:139], v[12:15], v[32:35]
    s_nop 0
    v_add_f32_dpp v83, v27, v83 row_ror:4 row_mask:0xf bank_mask:0x1
    v_mfma_f32_16x16x32_bf16 v[32:35], a[140:143], v[16:19], v[32:35]
    s_nop 0
    v_mov_b32_dpp v83, v28 row_ror:4 row_mask:0xf bank_mask:0x2
    v_mfma_f32_16x16x32_bf16 v[32:35], a[144:147], v[20:23], v[32:35]
    s_nop 0
    v_add_f32_dpp v83, v29, v83 quad_perm:[0,1,2,3] row_mask:0xf bank_mask:0x2
    v_mfma_f32_16x16x32_bf16 v[36:39], a[152:155], v[8:11], 0
    s_nop 0
    v_add_f32_dpp v83, v30, v83 row_ror:12 row_mask:0xf bank_mask:0x2
    v_mfma_f32_16x16x32_bf16 v[36:39], a[156:159], v[12:15], v[36:39]
    s_nop 0
    v_add_f32_dpp v83, v31, v83 row_ror:8 row_mask:0xf bank_mask:0x2
    v_mfma_f32_16x16x32_bf16 v[36:39], a[164:167], v[16:19], v[36:39]
    s_nop 0
    v_mov_b32_dpp v83, v32 row_ror:8 row_mask:0xf bank_mask:0x4
    v_mfma_f32_16x16x32_bf16 v[36:39], a[168:171], v[20:23], v[36:39]
    s_nop 0
    v_add_f32_dpp v83, v33, v83 row_ror:4 row_mask:0xf bank_mask:0x4
    v_mfma_f32_16x16x32_bf16 v[24:27], a[172:175], v[8:11], 0
    s_nop 0
    v_add_f32_dpp v83, v34, v83 quad_perm:[0,1,2,3] row_mask:0xf bank_mask:0x4
    s_waitcnt vmcnt(4)
    s_mov_b32 s52, 0xb6000
    buffer_load_dwordx4 a[216:219], v1, s[32:35], s52 offen offset:0 nt
    s_cmp_eq_u32 s58, 1
    s_cbranch_scc0 L_skip7
    s_atomic_add s30, s[26:27], 0
L_skip7:
    v_mfma_f32_16x16x32_bf16 v[24:27], a[180:183], v[12:15], v[24:27]
    v_add_f32_dpp v83, v35, v83 row_ror:12 row_mask:0xf bank_mask:0x4
    v_mfma_f32_16x16x32_bf16 v[24:27], a[184:187], v[16:19], v[24:27]
    s_nop 0
    v_mov_b32_dpp v83, v36 row_ror:12 row_mask:0xf bank_mask:0x8
    v_mfma_f32_16x16x32_bf16 v[24:27], a[192:195], v[20:23], v[24:27]
    s_nop 0
    v_add_f32_dpp v83, v37, v83 row_ror:8 row_mask:0xf bank_mask:0x8
    v_mfma_f32_16x16x32_bf16 v[28:31], a[196:199], v[8:11], 0
    s_nop 0
    v_add_f32_dpp v83, v38, v83 row_ror:4 row_mask:0xf bank_mask:0x8
    v_mfma_f32_16x16x32_bf16 v[28:31], a[200:203], v[12:15], v[28:31]
    s_nop 0
    v_add_f32_dpp v83, v39, v83 quad_perm:[0,1,2,3] row_mask:0xf bank_mask:0x8
    v_cvt_pk_bf16_f32 v41, v83, v83
    v_and_b32 v41, 0xffff0000, v41
    v_mul_f32 v41, 0x3db504f3, v41
    v_cvt_pk_bf16_f32 v41, v41, v41
    v_and_b32 v41, 0xffff0000, v41
    v_max_f32 v80, v80, v41
    v_mfma_f32_16x16x32_bf16 v[28:31], a[208:211], v[16:19], v[28:31]
    v_mov_b32_dpp v82, v24 quad_perm:[0,1,2,3] row_mask:0xf bank_mask:0x1
    v_mfma_f32_16x16x32_bf16 v[28:31], a[212:215], v[20:23], v[28:31]
    s_nop 0
    v_add_f32_dpp v82, v25, v82 row_ror:12 row_mask:0xf bank_mask:0x1
    v_mfma_f32_16x16x32_bf16 v[32:35], a[220:223], v[8:11], 0
    s_nop 0
    v_add_f32_dpp v82, v26, v82 row_ror:8 row_mask:0xf bank_mask:0x1
    v_mfma_f32_16x16x32_bf16 v[32:35], a[224:227], v[12:15], v[32:35]
    s_nop 0
    v_add_f32_dpp v82, v27, v82 row_ror:4 row_mask:0xf bank_mask:0x1
    s_waitcnt vmcnt(4)
    s_mov_b32 s52, 0xb7000
    buffer_load_dwordx4 v[144:147], v1, s[32:35], s52 offen offset:0 nt
    v_mfma_f32_16x16x32_bf16 v[32:35], a[228:231], v[16:19], v[32:35]
    v_mov_b32_dpp v82, v28 row_ror:4 row_mask:0xf bank_mask:0x2
    v_mfma_f32_16x16x32_bf16 v[32:35], a[236:239], v[20:23], v[32:35]
    s_nop 0
    v_add_f32_dpp v82, v29, v82 quad_perm:[0,1,2,3] row_mask:0xf bank_mask:0x2
    v_mfma_f32_16x16x32_bf16 v[36:39], a[240:243], v[8:11], 0
    s_nop 0
    v_add_f32_dpp v82, v30, v82 row_ror:12 row_mask:0xf bank_mask:0x2
    v_mfma_f32_16x16x32_bf16 v[36:39], a[248:251], v[12:15], v[36:39]
    s_nop 0
    v_add_f32_dpp v82, v31, v82 row_ror:8 row_mask:0xf bank_mask:0x2
    v_mfma_f32_16x16x32_bf16 v[36:39], a[252:255], v[16:19], v[36:39]
    s_nop 0
    v_mov_b32_dpp v82, v32 row_ror:8 row_mask:0xf bank_mask:0x4
    v_mfma_f32_16x16x32_bf16 v[36:39], v[128:131], v[20:23], v[36:39]
    s_nop 0
    v_add_f32_dpp v82, v33, v82 row_ror:4 row_mask:0xf bank_mask:0x4
    v_mfma_f32_16x16x32_bf16 v[24:27], v[136:139], v[8:11], 0
    s_nop 0
    v_add_f32_dpp v82, v34, v82 quad_perm:[0,1,2,3] row_mask:0xf bank_mask:0x4
    v_mfma_f32_16x16x32_bf16 v[24:27], v[140:143], v[12:15], v[24:27]
    s_nop 0
    v_add_f32_dpp v82, v35, v82 row_ror:12 row_mask:0xf bank_mask:0x4
    v_mfma_f32_16x16x32_bf16 v[24:27], v[148:151], v[16:19], v[24:27]
    s_nop 0
    v_mov_b32_dpp v82, v36 row_ror:12 row_mask:0xf bank_mask:0x8
    v_mfma_f32_16x16x32_bf16 v[24:27], v[152:155], v[20:23], v[24:27]
    s_nop 0
    v_add_f32_dpp v82, v37, v82 row_ror:8 row_mask:0xf bank_mask:0x8
    v_mfma_f32_16x16x32_bf16 v[28:31], v[156:159], v[8:11], 0
    s_nop 0
    v_add_f32_dpp v82, v38, v82 row_ror:4 row_mask:0xf bank_mask:0x8
    v_mfma_f32_16x16x32_bf16 v[28:31], v[164:167], v[12:15], v[28:31]
    s_nop 0
    v_add_f32_dpp v82, v39, v82 quad_perm:[0,1,2,3] row_mask:0xf bank_mask:0x8
    s_waitcnt vmcnt(4)
    s_mov_b32 s52, 0xc0000
    buffer_load_dwordx4 a[0:3], v1, s[32:35], s52 offen offset:0 nt
    s_cmp_eq_u32 s58, 2
    s_cbranch_scc0 L_skip8
    s_atomic_add s30, s[26:27], 0
L_skip8:
    v_cvt_pk_bf16_f32 v42, v82, v82
    v_and_b32 v42, 0xffff0000, v42
    v_mul_f32 v42, 0x3db504f3, v42
    v_cvt_pk_bf16_f32 v42, v42, v42
    v_and_b32 v42, 0xffff0000, v42
    v_max_f32 v80, v80, v42
    v_mfma_f32_16x16x32_bf16 v[28:31], v[168:171], v[16:19], v[28:31]
    v_mov_b32_dpp v83, v24 quad_perm:[0,1,2,3] row_mask:0xf bank_mask:0x1
    v_mfma_f32_16x16x32_bf16 v[28:31], v[176:179], v[20:23], v[28:31]
    s_nop 0
    v_add_f32_dpp v83, v25, v83 row_ror:12 row_mask:0xf bank_mask:0x1
    v_mfma_f32_16x16x32_bf16 v[32:35], v[180:183], v[8:11], 0
    s_nop 0
    v_add_f32_dpp v83, v26, v83 row_ror:8 row_mask:0xf bank_mask:0x1
    v_mfma_f32_16x16x32_bf16 v[32:35], v[184:187], v[12:15], v[32:35]
    s_nop 0
    v_add_f32_dpp v83, v27, v83 row_ror:4 row_mask:0xf bank_mask:0x1
    v_mfma_f32_16x16x32_bf16 v[32:35], v[192:195], v[16:19], v[32:35]
    s_nop 0
    v_mov_b32_dpp v83, v28 row_ror:4 row_mask:0xf bank_mask:0x2
    v_mfma_f32_16x16x32_bf16 v[32:35], v[196:199], v[20:23], v[32:35]
    s_nop 0
    v_add_f32_dpp v83, v29, v83 quad_perm:[0,1,2,3] row_mask:0xf bank_mask:0x2
    v_mfma_f32_16x16x32_bf16 v[36:39], v[204:207], v[8:11], 0
    s_nop 0
    v_add_f32_dpp v83, v30, v83 row_ror:12 row_mask:0xf bank_mask:0x2
    v_mfma_f32_16x16x32_bf16 v[36:39], v[208:211], v[12:15], v[36:39]
    s_nop 0
    v_add_f32_dpp v83, v31, v83 row_ror:8 row_mask:0xf bank_mask:0x2
    v_mfma_f32_16x16x32_bf16 v[36:39], v[212:215], v[16:19], v[36:39]
    s_nop 0
    v_mov_b32_dpp v83, v32 row_ror:8 row_mask:0xf bank_mask:0x4
    s_waitcnt vmcnt(4)
    s_mov_b32 s52, 0xc1000
    buffer_load_dwordx4 a[4:7], v1, s[32:35], s52 offen offset:0 nt
    v_mfma_f32_16x16x32_bf16 v[36:39], v[220:223], v[20:23], v[36:39]
    v_add_f32_dpp v83, v33, v83 row_ror:4 row_mask:0xf bank_mask:0x4
    v_mfma_f32_16x16x32_bf16 v[24:27], v[224:227], v[8:11], 0
    s_nop 0
    v_add_f32_dpp v83, v34, v83 quad_perm:[0,1,2,3] row_mask:0xf bank_mask:0x4
    v_mfma_f32_16x16x32_bf16 v[24:27], v[232:235], v[12:15], v[24:27]
    s_nop 0
    v_add_f32_dpp v83, v35, v83 row_ror:12 row_mask:0xf bank_mask:0x4
    v_mfma_f32_16x16x32_bf16 v[24:27], v[236:239], v[16:19], v[24:27]
    s_nop 0
    v_mov_b32_dpp v83, v36 row_ror:12 row_mask:0xf bank_mask:0x8
    v_mfma_f32_16x16x32_bf16 v[24:27], v[240:243], v[20:23], v[24:27]
    s_nop 0
    v_add_f32_dpp v83, v37, v83 row_ror:8 row_mask:0xf bank_mask:0x8
    v_mfma_f32_16x16x32_bf16 v[28:31], v[248:251], v[8:11], 0
    s_nop 0
    v_add_f32_dpp v83, v38, v83 row_ror:4 row_mask:0xf bank_mask:0x8
    v_mfma_f32_16x16x32_bf16 v[28:31], v[252:255], v[12:15], v[28:31]
    s_nop 0
    v_add_f32_dpp v83, v39, v83 quad_perm:[0,1,2,3] row_mask:0xf bank_mask:0x8
    v_cvt_pk_bf16_f32 v43, v83, v83
    v_and_b32 v43, 0xffff0000, v43
    v_mul_f32 v43, 0x3db504f3, v43
    v_cvt_pk_bf16_f32 v43, v43, v43
    v_and_b32 v43, 0xffff0000, v43
    v_max_f32 v80, v80, v43
    v_mfma_f32_16x16x32_bf16 v[28:31], a[36:39], v[16:19], v[28:31]
    v_mov_b32_dpp v82, v24 quad_perm:[0,1,2,3] row_mask:0xf bank_mask:0x1
    v_mfma_f32_16x16x32_bf16 v[28:31], a[48:51], v[20:23], v[28:31]
    s_nop 0
    v_add_f32_dpp v82, v25, v82 row_ror:12 row_mask:0xf bank_mask:0x1
    s_waitcnt vmcnt(4)
    s_mov_b32 s52, 0xc2000
    buffer_load_dwordx4 a[8:11], v1, s[32:35], s52 offen offset:0 nt
    s_cmp_eq_u32 s58, 3
    s_cbranch_scc0 L_skip9
    s_atomic_add s30, s[26:27], 0
L_skip9:
    v_mfma_f32_16x16x32_bf16 v[32:35], a[64:67], v[8:11], 0
    v_add_f32_dpp v82, v26, v82 row_ror:8 row_mask:0xf bank_mask:0x1
    v_mfma_f32_16x16x32_bf16 v[32:35], a[92:95], v[12:15], v[32:35]
    s_nop 0
    v_add_f32_dpp v82, v27, v82 row_ror:4 row_mask:0xf bank_mask:0x1
    v_mfma_f32_16x16x32_bf16 v[32:35], a[104:107], v[16:19], v[32:35]
    s_nop 0
    v_mov_b32_dpp v82, v28 row_ror:4 row_mask:0xf bank_mask:0x2
    v_mfma_f32_16x16x32_bf16 v[32:35], a[132:135], v[20:23], v[32:35]
    s_nop 0
    v_add_f32_dpp v82, v29, v82 quad_perm:[0,1,2,3] row_mask:0xf bank_mask:0x2
    v_mfma_f32_16x16x32_bf16 v[36:39], a[148:151], v[8:11], 0
    s_nop 0
    v_add_f32_dpp v82, v30, v82 row_ror:12 row_mask:0xf bank_mask:0x2
    v_mfma_f32_16x16x32_bf16 v[36:39], a[160:163], v[12:15], v[36:39]
    s_nop 0
    v_add_f32_dpp v82, v31, v82 row_ror:8 row_mask:0xf bank_mask:0x2
    v_mfma_f32_16x16x32_bf16 v[36:39], a[188:191], v[16:19], v[36:39]
    s_nop 0
    v_mov_b32_dpp v82, v32 row_ror:8 row_mask:0xf bank_mask:0x4
    v_mfma_f32_16x16x32_bf16 v[36:39], a[204:207], v[20:23], v[36:39]
    s_nop 0
    v_add_f32_dpp v82, v33, v82 row_ror:4 row_mask:0xf bank_mask:0x4
    v_mfma_f32_16x16x32_bf16 v[24:27], a[232:235], v[8:11], 0
    s_nop 0
    v_add_f32_dpp v82, v34, v82 quad_perm:[0,1,2,3] row_mask:0xf bank_mask:0x4
    v_mfma_f32_16x16x32_bf16 v[24:27], a[244:247], v[12:15], v[24:27]
    s_nop 0
    v_add_f32_dpp v82, v35, v82 row_ror:12 row_mask:0xf bank_mask:0x4
    v_mfma_f32_16x16x32_bf16 v[24:27], v[132:135], v[16:19], v[24:27]
    s_nop 0
    v_mov_b32_dpp v82, v36 row_ror:12 row_mask:0xf bank_mask:0x8
    v_mfma_f32_16x16x32_bf16 v[24:27], v[160:163], v[20:23], v[24:27]
    s_nop 0
    v_add_f32_dpp v82, v37, v82 row_ror:8 row_mask:0xf bank_mask:0x8
    s_waitcnt vmcnt(4)
    s_mov_b32 s52, 0xc3000
    buffer_load_dwordx4 a[12:15], v1, s[32:35], s52 offen offset:0 nt
    v_mfma_f32_16x16x32_bf16 v[28:31], v[172:175], v[8:11], 0
    v_add_f32_dpp v82, v38, v82 row_ror:4 row_mask:0xf bank_mask:0x8
    v_mfma_f32_16x16x32_bf16 v[28:31], v[188:191], v[12:15], v[28:31]
    s_nop 0
    v_add_f32_dpp v82, v39, v82 quad_perm:[0,1,2,3] row_mask:0xf bank_mask:0x8
    v_cvt_pk_bf16_f32 v44, v82, v82
    v_and_b32 v44, 0xffff0000, v44
    v_mul_f32 v44, 0x3db504f3, v44
    v_cvt_pk_bf16_f32 v44, v44, v44
    v_and_b32 v44, 0xffff0000, v44
    v_max_f32 v80, v80, v44
    v_mfma_f32_16x16x32_bf16 v[28:31], v[200:203], v[16:19], v[28:31]
    v_mov_b32_dpp v83, v24 quad_perm:[0,1,2,3] row_mask:0xf bank_mask:0x1
    v_mfma_f32_16x16x32_bf16 v[28:31], v[216:219], v[20:23], v[28:31]
    s_nop 0
    v_add_f32_dpp v83, v25, v83 row_ror:12 row_mask:0xf bank_mask:0x1
    v_mfma_f32_16x16x32_bf16 v[32:35], v[228:231], v[8:11], 0
    s_nop 0
    v_add_f32_dpp v83, v26, v83 row_ror:8 row_mask:0xf bank_mask:0x1
    v_mfma_f32_16x16x32_bf16 v[32:35], v[244:247], v[12:15], v[32:35]
    s_nop 0
    v_add_f32_dpp v83, v27, v83 row_ror:4 row_mask:0xf bank_mask:0x1
    v_mfma_f32_16x16x32_bf16 v[32:35], a[20:23], v[16:19], v[32:35]
    s_nop 0
    v_mov_b32_dpp v83, v28 row_ror:4 row_mask:0xf bank_mask:0x2
    v_mfma_f32_16x16x32_bf16 v[32:35], a[76:79], v[20:23], v[32:35]
    s_nop 0
    v_add_f32_dpp v83, v29, v83 quad_perm:[0,1,2,3] row_mask:0xf bank_mask:0x2
    v_mfma_f32_16x16x32_bf16 v[36:39], a[120:123], v[8:11], 0
    s_nop 0
    v_add_f32_dpp v83, v30, v83 row_ror:12 row_mask:0xf bank_mask:0x2
    s_waitcnt vmcnt(4)
    s_mov_b32 s52, 0xc4000
    buffer_load_dwordx4 a[16:19], v1, s[32:35], s52 offen offset:0 nt
    s_cmp_eq_u32 s58, 4
    s_cbranch_scc0 L_skip10
    s_atomic_add s30, s[26:27], 0
L_skip10:
    v_mfma_f32_16x16x32_bf16 v[36:39], a[176:179], v[12:15], v[36:39]
    v_add_f32_dpp v83, v31, v83 row_ror:8 row_mask:0xf bank_mask:0x2
    v_mfma_f32_16x16x32_bf16 v[36:39], a[216:219], v[16:19], v[36:39]
    s_nop 0
    v_mov_b32_dpp v83, v32 row_ror:8 row_mask:0xf bank_mask:0x4
    v_mfma_f32_16x16x32_bf16 v[36:39], v[144:147], v[20:23], v[36:39]
    s_nop 0
    v_add_f32_dpp v83, v33, v83 row_ror:4 row_mask:0xf bank_mask:0x4
    s_waitcnt vmcnt(4)
    s_mov_b32 s52, 0xc5000
    buffer_load_dwordx4 a[24:27], v1, s[32:35], s52 offen offset:0 nt
    v_mfma_f32_16x16x32_bf16 v[24:27], a[0:3], v[8:11], 0
    v_add_f32_dpp v83, v34, v83 quad_perm:[0,1,2,3] row_mask:0xf bank_mask:0x4
    s_waitcnt vmcnt(4)
    s_mov_b32 s52, 0xc6000
    buffer_load_dwordx4 a[28:31], v1, s[32:35], s52 offen offset:0 nt
    s_cmp_eq_u32 s58, 5
    s_cbranch_scc0 L_skip11
    s_atomic_add s30, s[26:27], 0
L_skip11:
    v_mfma_f32_16x16x32_bf16 v[24:27], a[4:7], v[12:15], v[24:27]
    v_add_f32_dpp v83, v35, v83 row_ror:12 row_mask:0xf bank_mask:0x4
    s_waitcnt vmcnt(4)
    s_mov_b32 s52, 0xc7000
    buffer_load_dwordx4 a[32:35], v1, s[32:35], s52 offen offset:0 nt
    v_mfma_f32_16x16x32_bf16 v[24:27], a[8:11], v[16:19], v[24:27]
    v_mov_b32_dpp v83, v36 row_ror:12 row_mask:0xf bank_mask:0x8
    s_waitcnt vmcnt(4)
    s_mov_b32 s52, 0xd0000
    buffer_load_dwordx4 a[40:43], v1, s[32:35], s52 offen offset:0 nt
    s_cmp_eq_u32 s58, 6
    s_cbranch_scc0 L_skip12
    s_atomic_add s30, s[26:27], 0
L_skip12:
    v_mfma_f32_16x16x32_bf16 v[24:27], a[12:15], v[20:23], v[24:27]
    v_add_f32_dpp v83, v37, v83 row_ror:8 row_mask:0xf bank_mask:0x8
    s_waitcnt vmcnt(4)
    s_mov_b32 s52, 0xd1000
    buffer_load_dwordx4 a[44:47], v1, s[32:35], s52 offen offset:0 nt
    v_mfma_f32_16x16x32_bf16 v[28:31], a[16:19], v[8:11], 0
    v_add_f32_dpp v83, v38, v83 row_ror:4 row_mask:0xf bank_mask:0x8
    s_waitcnt vmcnt(4)
    s_mov_b32 s52, 0xd2000
    buffer_load_dwordx4 a[52:55], v1, s[32:35], s52 offen offset:0 nt
    s_cmp_eq_u32 s58, 7
    s_cbranch_scc0 L_skip13
    s_atomic_add s30, s[26:27], 0
L_skip13:
    v_mfma_f32_16x16x32_bf16 v[28:31], a[24:27], v[12:15], v[28:31]
    v_add_f32_dpp v83, v39, v83 quad_perm:[0,1,2,3] row_mask:0xf bank_mask:0x8
    v_cvt_pk_bf16_f32 v45, v83, v83
    v_and_b32 v45, 0xffff0000, v45
    v_mul_f32 v45, 0x3db504f3, v45
    v_cvt_pk_bf16_f32 v45, v45, v45
    v_and_b32 v45, 0xffff0000, v45
    v_max_f32 v80, v80, v45
    s_waitcnt vmcnt(4)
    s_mov_b32 s52, 0xd3000
    buffer_load_dwordx4 a[56:59], v1, s[32:35], s52 offen offset:0 nt
    v_mfma_f32_16x16x32_bf16 v[28:31], a[28:31], v[16:19], v[28:31]
    v_mov_b32_dpp v82, v24 quad_perm:[0,1,2,3] row_mask:0xf bank_mask:0x1
    s_waitcnt vmcnt(4)
    s_mov_b32 s52, 0xd4000
    buffer_load_dwordx4 a[60:63], v1, s[32:35], s52 offen offset:0 nt
    s_cmp_eq_u32 s58, 8
    s_cbranch_scc0 L_skip14
    s_atomic_add s30, s[26:27], 0
L_skip14:
    v_mfma_f32_16x16x32_bf16 v[28:31], a[32:35], v[20:23], v[28:31]
    v_add_f32_dpp v82, v25, v82 row_ror:12 row_mask:0xf bank_mask:0x1
    s_waitcnt vmcnt(4)
    s_mov_b32 s52, 0xd5000
    buffer_load_dwordx4 a[68:71], v1, s[32:35], s52 offen offset:0 nt
    v_mfma_f32_16x16x32_bf16 v[32:35], a[40:43], v[8:11], 0
    v_add_f32_dpp v82, v26, v82 row_ror:8 row_mask:0xf bank_mask:0x1
    s_waitcnt vmcnt(4)
    s_mov_b32 s52, 0xd6000
    buffer_load_dwordx4 a[72:75], v1, s[32:35], s52 offen offset:0 nt
    s_cmp_eq_u32 s58, 9
    s_cbranch_scc0 L_skip15
    s_atomic_add s30, s[26:27], 0
L_skip15:
    v_mfma_f32_16x16x32_bf16 v[32:35], a[44:47], v[12:15], v[32:35]
    v_add_f32_dpp v82, v27, v82 row_ror:4 row_mask:0xf bank_mask:0x1
    s_waitcnt vmcnt(4)
    s_mov_b32 s52, 0xd7000
    buffer_load_dwordx4 a[80:83], v1, s[32:35], s52 offen offset:0 nt
    v_mfma_f32_16x16x32_bf16 v[32:35], a[52:55], v[16:19], v[32:35]
    v_mov_b32_dpp v82, v28 row_ror:4 row_mask:0xf bank_mask:0x2
    s_waitcnt vmcnt(4)
    s_mov_b32 s52, 0xe0000
    buffer_load_dwordx4 a[84:87], v1, s[32:35], s52 offen offset:0 nt
    s_cmp_eq_u32 s58, 10
    s_cbranch_scc0 L_skip16
    s_atomic_add s30, s[26:27], 0
L_skip16:
    v_mfma_f32_16x16x32_bf16 v[32:35], a[56:59], v[20:23], v[32:35]
    v_add_f32_dpp v82, v29, v82 quad_perm:[0,1,2,3] row_mask:0xf bank_mask:0x2
    s_waitcnt vmcnt(4)
    s_mov_b32 s52, 0xe1000
    buffer_load_dwordx4 a[88:91], v1, s[32:35], s52 offen offset:0 nt
    v_mfma_f32_16x16x32_bf16 v[36:39], a[60:63], v[8:11], 0
    v_add_f32_dpp v82, v30, v82 row_ror:12 row_mask:0xf bank_mask:0x2
    s_waitcnt vmcnt(4)
    s_mov_b32 s52, 0xe2000
    buffer_load_dwordx4 a[96:99], v1, s[32:35], s52 offen offset:0 nt
    s_cmp_eq_u32 s58, 11
    s_cbranch_scc0 L_skip17
    s_atomic_add s30, s[26:27], 0
L_skip17:
    v_mfma_f32_16x16x32_bf16 v[36:39], a[68:71], v[12:15], v[36:39]
    v_add_f32_dpp v82, v31, v82 row_ror:8 row_mask:0xf bank_mask:0x2
    s_waitcnt vmcnt(4)
    s_mov_b32 s52, 0xe3000
    buffer_load_dwordx4 a[100:103], v1, s[32:35], s52 offen offset:0 nt
    v_mfma_f32_16x16x32_bf16 v[36:39], a[72:75], v[16:19], v[36:39]
    v_mov_b32_dpp v82, v32 row_ror:8 row_mask:0xf bank_mask:0x4
    s_waitcnt vmcnt(4)
    s_mov_b32 s52, 0xe4000
    buffer_load_dwordx4 a[108:111], v1, s[32:35], s52 offen offset:0 nt
    s_cmp_eq_u32 s58, 12
    s_cbranch_scc0 L_skip18
    s_atomic_add s30, s[26:27], 0
L_skip18:
    v_mfma_f32_16x16x32_bf16 v[36:39], a[80:83], v[20:23], v[36:39]
    v_add_f32_dpp v82, v33, v82 row_ror:4 row_mask:0xf bank_mask:0x4
    s_waitcnt vmcnt(4)
    s_mov_b32 s52, 0xe5000
    buffer_load_dwordx4 a[112:115], v1, s[32:35], s52 offen offset:0 nt
    v_mfma_f32_16x16x32_bf16 v[24:27], a[84:87], v[8:11], 0
    v_add_f32_dpp v82, v34, v82 quad_perm:[0,1,2,3] row_mask:0xf bank_mask:0x4
    s_waitcnt vmcnt(4)
    s_mov_b32 s52, 0xe6000
    buffer_load_dwordx4 a[116:119], v1, s[32:35], s52 offen offset:0 nt
    s_cmp_eq_u32 s58, 13
    s_cbranch_scc0 L_skip19
    s_atomic_add s30, s[26:27], 0
L_skip19:
    v_mfma_f32_16x16x32_bf16 v[24:27], a[88:91], v[12:15], v[24:27]
    v_add_f32_dpp v82, v35, v82 row_ror:12 row_mask:0xf bank_mask:0x4
    s_waitcnt vmcnt(4)
    s_mov_b32 s52, 0xe7000
    buffer_load_dwordx4 a[124:127], v1, s[32:35], s52 offen offset:0 nt
    v_mfma_f32_16x16x32_bf16 v[24:27], a[96:99], v[16:19], v[24:27]
    v_mov_b32_dpp v82, v36 row_ror:12 row_mask:0xf bank_mask:0x8
    s_waitcnt vmcnt(4)
    s_mov_b32 s52, 0xf0000
    buffer_load_dwordx4 a[128:131], v1, s[32:35], s52 offen offset:0 nt
    s_cmp_eq_u32 s58, 14
    s_cbranch_scc0 L_skip20
    s_atomic_add s30, s[26:27], 0
L_skip20:
    v_mfma_f32_16x16x32_bf16 v[24:27], a[100:103], v[20:23], v[24:27]
    v_add_f32_dpp v82, v37, v82 row_ror:8 row_mask:0xf bank_mask:0x8
    s_and_b32 s55, s3, 1
    s_mul_i32 s55, s55, 1792
    v_mul_u32_u24 v84, 28, v0
    v_add_u32 v84, s55, v84
    global_load_dwordx4 v[96:99], v84, s[16:17]
    s_waitcnt vmcnt(5)
    s_mov_b32 s52, 0xf1000
    buffer_load_dwordx4 a[136:139], v1, s[32:35], s52 offen offset:0 nt
    v_mfma_f32_16x16x32_bf16 v[28:31], a[108:111], v[8:11], 0
    v_add_f32_dpp v82, v38, v82 row_ror:4 row_mask:0xf bank_mask:0x8
    global_load_dwordx3 v[100:102], v84, s[16:17] offset:16
    global_load_dwordx4 v[104:107], v84, s[18:19]
    global_load_dwordx3 v[108:110], v84, s[18:19] offset:16
    global_load_dwordx4 v[112:115], v84, s[20:21]
    global_load_dwordx3 v[116:118], v84, s[20:21] offset:16
    s_waitcnt vmcnt(10)
    s_mov_b32 s52, 0xf2000
    buffer_load_dwordx4 a[140:143], v1, s[32:35], s52 offen offset:0 nt
    s_cmp_eq_u32 s58, 15
    s_cbranch_scc0 L_skip21
    s_atomic_add s30, s[26:27], 0
L_skip21:
    v_mfma_f32_16x16x32_bf16 v[28:31], a[112:115], v[12:15], v[28:31]
    v_add_f32_dpp v82, v39, v82 quad_perm:[0,1,2,3] row_mask:0xf bank_mask:0x8
    v_cvt_pk_bf16_f32 v46, v82, v82
    v_and_b32 v46, 0xffff0000, v46
    v_mul_f32 v46, 0x3db504f3, v46
    v_cvt_pk_bf16_f32 v46, v46, v46
    v_and_b32 v46, 0xffff0000, v46
    v_max_f32 v80, v80, v46
    v_add_f32 v85, v88, v89
    v_add_f32 v84, v90, v91
    v_add_f32 v86, v92, v93
    v_add_f32 v87, v94, v95
    v_add_f32 v85, v85, v84
    s_waitcnt vmcnt(10)
    s_mov_b32 s52, 0xf3000
    buffer_load_dwordx4 a[144:147], v1, s[32:35], s52 offen offset:0 nt
    v_mfma_f32_16x16x32_bf16 v[28:31], a[116:119], v[16:19], v[28:31]
    v_mov_b32_dpp v83, v24 quad_perm:[0,1,2,3] row_mask:0xf bank_mask:0x1
    v_add_f32 v86, v86, v87
    v_add_f32 v85, v85, v86
    s_nop 1
    v_add_f32_dpp v85, v85, v85 quad_perm:[1,0,3,2] row_mask:0xf bank_mask:0xf
    s_nop 1
    v_add_f32_dpp v85, v85, v85 quad_perm:[2,3,0,1] row_mask:0xf bank_mask:0xf
    s_nop 1
    v_add_f32_dpp v85, v85, v85 row_half_mirror row_mask:0xf bank_mask:0xf
    s_waitcnt vmcnt(10)
    s_mov_b32 s52, 0xf4000
    buffer_load_dwordx4 a[152:155], v1, s[32:35], s52 offen offset:0 nt
    s_cmp_eq_u32 s58, 16
    s_cbranch_scc0 L_skip22
    s_atomic_add s30, s[26:27], 0
L_skip22:
    v_mfma_f32_16x16x32_bf16 v[28:31], a[124:127], v[20:23], v[28:31]
    v_add_f32_dpp v83, v25, v83 row_ror:12 row_mask:0xf bank_mask:0x1
    v_add_f32_dpp v85, v85, v85 row_mirror row_mask:0xf bank_mask:0xf
    v_mov_b32 v84, v85
    s_nop 1
    v_permlane16_swap_b32 v85, v84
    v_add_f32 v85, v85, v84
    v_mov_b32 v84, v85
    s_waitcnt vmcnt(10)
    s_mov_b32 s52, 0xf5000
    buffer_load_dwordx4 a[156:159], v1, s[32:35], s52 offen offset:0 nt
    v_mfma_f32_16x16x32_bf16 v[32:35], a[128:131], v[8:11], 0
    v_add_f32_dpp v83, v26, v83 row_ror:8 row_mask:0xf bank_mask:0x1
    v_permlane32_swap_b32 v85, v84
    v_add_f32 v85, v85, v84
    v_mul_f32 v85, 0x3b000000, v85
    v_sub_f32 v84, v88, v85
    v_mul_f32 v86, v84, v84
    s_waitcnt vmcnt(9)
    s_mov_b32 s52, 0xf6000
    buffer_load_dwordx4 a[164:167], v1, s[32:35], s52 offen offset:0 nt
    s_cmp_eq_u32 s58, 17
    s_cbranch_scc0 L_skip23
    s_atomic_add s30, s[26:27], 0
L_skip23:
    v_mfma_f32_16x16x32_bf16 v[32:35], a[136:139], v[12:15], v[32:35]
    v_add_f32_dpp v83, v27, v83 row_ror:4 row_mask:0xf bank_mask:0x1
    v_sub_f32 v84, v89, v85
    v_fmac_f32 v86, v84, v84
    v_sub_f32 v84, v90, v85
    v_fmac_f32 v86, v84, v84
    v_sub_f32 v84, v91, v85
    s_waitcnt vmcnt(4)
    s_mov_b32 s52, 0xf7000
    buffer_load_dwordx4 a[168:171], v1, s[32:35], s52 offen offset:0 nt
    v_mfma_f32_16x16x32_bf16 v[32:35], a[140:143], v[16:19], v[32:35]
    v_mov_b32_dpp v83, v28 row_ror:4 row_mask:0xf bank_mask:0x2
    v_fmac_f32 v86, v84, v84
    v_sub_f32 v84, v92, v85
    v_fmac_f32 v86, v84, v84
    v_sub_f32 v84, v93, v85
    v_fmac_f32 v86, v84, v84
    s_waitcnt vmcnt(4)
    s_mov_b32 s52, 0x100000
    buffer_load_dwordx4 a[172:175], v1, s[32:35], s52 offen offset:0 nt
    s_cmp_eq_u32 s58, 18
    s_cbranch_scc0 L_skip24
    s_atomic_add s30, s[26:27], 0
L_skip24:
    v_mfma_f32_16x16x32_bf16 v[32:35], a[144:147], v[20:23], v[32:35]
    v_add_f32_dpp v83, v29, v83 quad_perm:[0,1,2,3] row_mask:0xf bank_mask:0x2
    v_sub_f32 v84, v94, v85
    v_fmac_f32 v86, v84, v84
    v_sub_f32 v84, v95, v85
    v_fmac_f32 v86, v84, v84
    s_nop 1
    v_add_f32_dpp v86, v86, v86 quad_perm:[1,0,3,2] row_mask:0xf bank_mask:0xf
    s_waitcnt vmcnt(4)
    s_mov_b32 s52, 0x101000
    buffer_load_dwordx4 a[180:183], v1, s[32:35], s52 offen offset:0 nt
    v_mfma_f32_16x16x32_bf16 v[36:39], a[152:155], v[8:11], 0
    v_add_f32_dpp v83, v30, v83 row_ror:12 row_mask:0xf bank_mask:0x2
    v_add_f32_dpp v86, v86, v86 quad_perm:[2,3,0,1] row_mask:0xf bank_mask:0xf
    s_nop 1
    v_add_f32_dpp v86, v86, v86 row_half_mirror row_mask:0xf bank_mask:0xf
    s_nop 1
    v_add_f32_dpp v86, v86, v86 row_mirror row_mask:0xf bank_mask:0xf
    v_mov_b32 v84, v86
    s_nop 1
    v_permlane16_swap_b32 v86, v84
    s_waitcnt vmcnt(4)
    s_mov_b32 s52, 0x102000
    buffer_load_dwordx4 a[184:187], v1, s[32:35], s52 offen offset:0 nt
    s_cmp_eq_u32 s58, 19
    s_cbranch_scc0 L_skip25
    s_atomic_add s30, s[26:27], 0
L_skip25:
    v_mfma_f32_16x16x32_bf16 v[36:39], a[156:159], v[12:15], v[36:39]
    v_add_f32_dpp v83, v31, v83 row_ror:8 row_mask:0xf bank_mask:0x2
    v_add_f32 v86, v86, v84
    v_mov_b32 v84, v86
    s_nop 1
    v_permlane32_swap_b32 v86, v84
    v_add_f32 v86, v86, v84
    v_mul_f32 v86, 0x3b000000, v86
    s_waitcnt vmcnt(4)
    s_mov_b32 s52, 0x103000
    buffer_load_dwordx4 a[192:195], v1, s[32:35], s52 offen offset:0 nt
    v_mfma_f32_16x16x32_bf16 v[36:39], a[164:167], v[16:19], v[36:39]
    v_mov_b32_dpp v83, v32 row_ror:8 row_mask:0xf bank_mask:0x4
    v_cvt_pk_bf16_f32 v84, v85, v86
    v_lshlrev_b32 v85, 16, v84
    v_and_b32 v86, 0xffff0000, v84
    v_add_f32 v86, 0x3727c5ac, v86
    v_cvt_pk_bf16_f32 v86, v86, v86
    s_waitcnt vmcnt(4)
    s_mov_b32 s52, 0x104000
    buffer_load_dwordx4 a[196:199], v1, s[32:35], s52 offen offset:0 nt
    s_cmp_eq_u32 s58, 20
    s_cbranch_scc0 L_skip26
    s_atomic_add s30, s[26:27], 0
L_skip26:
    v_mfma_f32_16x16x32_bf16 v[36:39], a[168:171], v[20:23], v[36:39]
    v_add_f32_dpp v83, v33, v83 row_ror:4 row_mask:0xf bank_mask:0x4
    v_and_b32 v86, 0xffff0000, v86
    v_sqrt_f32 v86, v86
    s_nop 0
    v_cvt_pk_bf16_f32 v86, v86, v86
    v_and_b32 v86, 0xffff0000, v86
    v_rcp_f32 v86, v86
    s_waitcnt vmcnt(4)
    s_mov_b32 s52, 0x105000
    buffer_load_dwordx4 a[200:203], v1, s[32:35], s52 offen offset:0 nt
    v_mfma_f32_16x16x32_bf16 v[24:27], a[172:175], v[8:11], 0
    v_add_f32_dpp v83, v34, v83 quad_perm:[0,1,2,3] row_mask:0xf bank_mask:0x4
    v_sub_f32 v122, v122, v85
    v_sub_f32 v120, v120, v85
    v_cvt_pk_bf16_f32 v84, v122, v120
    v_lshlrev_b32 v122, 16, v84
    v_and_b32 v120, 0xffff0000, v84
    s_waitcnt vmcnt(4)
    s_mov_b32 s52, 0x106000
    buffer_load_dwordx4 a[208:211], v1, s[32:35], s52 offen offset:0 nt
    s_cmp_eq_u32 s58, 21
    s_cbranch_scc0 L_skip27
    s_atomic_add s30, s[26:27], 0
L_skip27:
    v_mfma_f32_16x16x32_bf16 v[24:27], a[180:183], v[12:15], v[24:27]
    v_add_f32_dpp v83, v35, v83 row_ror:12 row_mask:0xf bank_mask:0x4
    v_mul_f32 v122, v122, v86
    v_mul_f32 v120, v120, v86
    v_cvt_pk_bf16_f32 v84, v122, v120
    v_lshlrev_b32 v122, 16, v84
    v_and_b32 v120, 0xffff0000, v84
    s_waitcnt vmcnt(4)
    s_mov_b32 s52, 0x107000
    buffer_load_dwordx4 a[212:215], v1, s[32:35], s52 offen offset:0 nt
    v_mfma_f32_16x16x32_bf16 v[24:27], a[184:187], v[16:19], v[24:27]
    v_mov_b32_dpp v83, v36 row_ror:12 row_mask:0xf bank_mask:0x8
    v_lshlrev_b32 v88, 16, v96
    v_and_b32 v89, 0xffff0000, v96
    v_mul_f32 v88, v122, v88
    v_mul_f32 v89, v122, v89
    v_cvt_pk_bf16_f32 v84, v88, v89
    s_waitcnt vmcnt(4)
    s_mov_b32 s52, 0x110000
    buffer_load_dwordx4 a[220:223], v1, s[32:35], s52 offen offset:0 nt
    s_cmp_eq_u32 s58, 22
    s_cbranch_scc0 L_skip28
    s_atomic_add s30, s[26:27], 0
L_skip28:
    v_mfma_f32_16x16x32_bf16 v[24:27], a[192:195], v[20:23], v[24:27]
    v_add_f32_dpp v83, v37, v83 row_ror:8 row_mask:0xf bank_mask:0x8
    v_lshlrev_b32 v88, 16, v84
    v_and_b32 v89, 0xffff0000, v84
    v_lshlrev_b32 v90, 16, v104
    v_and_b32 v91, 0xffff0000, v104
    v_add_f32 v88, v88, v90
    s_waitcnt vmcnt(4)
    s_mov_b32 s52, 0x111000
    buffer_load_dwordx4 a[224:227], v1, s[32:35], s52 offen offset:0 nt
    v_mfma_f32_16x16x32_bf16 v[28:31], a[196:199], v[8:11], 0
    v_add_f32_dpp v83, v38, v83 row_ror:4 row_mask:0xf bank_mask:0x8
    v_add_f32 v89, v89, v91
    v_cvt_pk_bf16_f32 v84, v88, v89
    v_lshlrev_b32 v88, 16, v84
    v_and_b32 v89, 0xffff0000, v84
    v_mov_b32 v85, 0xc0135761
    s_waitcnt vmcnt(4)
    s_mov_b32 s52, 0x112000
    buffer_load_dwordx4 a[228:231], v1, s[32:35], s52 offen offset:0 nt
    s_cmp_eq_u32 s58, 23
    s_cbranch_scc0 L_skip29
    s_atomic_add s30, s[26:27], 0
L_skip29:
    v_mfma_f32_16x16x32_bf16 v[28:31], a[200:203], v[12:15], v[28:31]
    v_add_f32_dpp v83, v39, v83 quad_perm:[0,1,2,3] row_mask:0xf bank_mask:0x8
    v_cvt_pk_bf16_f32 v47, v83, v83
    v_and_b32 v47, 0xffff0000, v47
    v_mul_f32 v47, 0x3db504f3, v47
    v_cvt_pk_bf16_f32 v47, v47, v47
    v_and_b32 v47, 0xffff0000, v47
    v_max_f32 v80, v80, v47
    v_mul_f32 v90, v88, v88
    v_mul_f32 v91, v89, v89
    v_fmamk_f32 v90, v90, 0xbdd2d3e8, v85
    v_fmamk_f32 v91, v91, 0xbdd2d3e8, v85
    v_mul_f32 v90, v90, v88
    s_waitcnt vmcnt(4)
    s_mov_b32 s52, 0x113000
    buffer_load_dwordx4 a[236:239], v1, s[32:35], s52 offen offset:0 nt
    v_mfma_f32_16x16x32_bf16 v[28:31], a[208:211], v[16:19], v[28:31]
    v_mov_b32_dpp v82, v24 quad_perm:[0,1,2,3] row_mask:0xf bank_mask:0x1
    v_mul_f32 v91, v91, v89
    v_exp_f32 v90, v90
    v_exp_f32 v91, v91
    v_add_f32 v90, 1.0, v90
    v_add_f32 v91, 1.0, v91
    s_waitcnt vmcnt(4)
    s_mov_b32 s52, 0x114000
    buffer_load_dwordx4 a[240:243], v1, s[32:35], s52 offen offset:0 nt
    s_mov_b32 s54, 0x0
    buffer_load_dwordx4 v[128:131], v4, s[44:47], s54 offen
    s_cmp_eq_u32 s58, 24
    s_cbranch_scc0 L_skip30
    s_atomic_add s30, s[26:27], 0
L_skip30:
    v_mfma_f32_16x16x32_bf16 v[28:31], a[212:215], v[20:23], v[28:31]
    v_add_f32_dpp v82, v25, v82 row_ror:12 row_mask:0xf bank_mask:0x1
    v_rcp_f32 v90, v90
    v_rcp_f32 v91, v91
    v_mul_f32 v88, v88, v90
    v_mul_f32 v89, v89, v91
    v_cvt_pk_bf16_f32 v84, v88, v89
    s_waitcnt vmcnt(5)
    s_mov_b32 s52, 0x115000
    buffer_load_dwordx4 a[248:251], v1, s[32:35], s52 offen offset:0 nt
    v_mfma_f32_16x16x32_bf16 v[32:35], a[220:223], v[8:11], 0
    v_add_f32_dpp v82, v26, v82 row_ror:8 row_mask:0xf bank_mask:0x1
    v_lshlrev_b32 v88, 16, v84
    v_and_b32 v89, 0xffff0000, v84
    v_lshlrev_b32 v90, 16, v112
    v_and_b32 v91, 0xffff0000, v112
    v_mul_f32 v121, v88, v90
    s_waitcnt vmcnt(5)
    s_mov_b32 s52, 0x116000
    buffer_load_dwordx4 a[252:255], v1, s[32:35], s52 offen offset:0 nt
    s_cmp_eq_u32 s58, 25
    s_cbranch_scc0 L_skip31
    s_atomic_add s30, s[26:27], 0
L_skip31:
    v_mfma_f32_16x16x32_bf16 v[32:35], a[224:227], v[12:15], v[32:35]
    v_add_f32_dpp v82, v27, v82 row_ror:4 row_mask:0xf bank_mask:0x1
    v_fmac_f32 v121, v89, v91
    v_lshlrev_b32 v88, 16, v97
    v_and_b32 v89, 0xffff0000, v97
    v_mul_f32 v88, v122, v88
    v_mul_f32 v89, v122, v89
    s_waitcnt vmcnt(5)
    s_mov_b32 s52, 0x117000
    buffer_load_dwordx4 a[36:39], v1, s[32:35], s52 offen offset:0 nt
    v_mfma_f32_16x16x32_bf16 v[32:35], a[228:231], v[16:19], v[32:35]
    v_mov_b32_dpp v82, v28 row_ror:4 row_mask:0xf bank_mask:0x2
    v_cvt_pk_bf16_f32 v84, v88, v89
    v_lshlrev_b32 v88, 16, v84
    v_and_b32 v89, 0xffff0000, v84
    v_lshlrev_b32 v90, 16, v105
    v_and_b32 v91, 0xffff0000, v105
    s_waitcnt vmcnt(5)
    s_mov_b32 s52, 0x120000
    buffer_load_dwordx4 a[48:51], v1, s[32:35], s52 offen offset:0 nt
    s_cmp_eq_u32 s58, 26
    s_cbranch_scc0 L_skip32
    s_atomic_add s30, s[26:27], 0
L_skip32:
    v_mfma_f32_16x16x32_bf16 v[32:35], a[236:239], v[20:23], v[32:35]
    v_add_f32_dpp v82, v29, v82 quad_perm:[0,1,2,3] row_mask:0xf bank_mask:0x2
    v_add_f32 v88, v88, v90
    v_add_f32 v89, v89, v91
    v_cvt_pk_bf16_f32 v84, v88, v89
    v_lshlrev_b32 v88, 16, v84
    v_and_b32 v89, 0xffff0000, v84
    s_waitcnt vmcnt(5)
    s_mov_b32 s52, 0x121000
    buffer_load_dwordx4 a[64:67], v1, s[32:35], s52 offen offset:0 nt
    v_mfma_f32_16x16x32_bf16 v[36:39], a[240:243], v[8:11], 0
    v_add_f32_dpp v82, v30, v82 row_ror:12 row_mask:0xf bank_mask:0x2
    v_mov_b32 v85, 0xc0135761
    v_mul_f32 v90, v88, v88
    v_mul_f32 v91, v89, v89
    v_fmamk_f32 v90, v90, 0xbdd2d3e8, v85
    v_fmamk_f32 v91, v91, 0xbdd2d3e8, v85
    s_waitcnt vmcnt(4)
    s_mov_b32 s52, 0x122000
    buffer_load_dwordx4 a[92:95], v1, s[32:35], s52 offen offset:0 nt
    s_cmp_eq_u32 s58, 27
    s_cbranch_scc0 L_skip33
    s_atomic_add s30, s[26:27], 0
L_skip33:
    v_mfma_f32_16x16x32_bf16 v[36:39], a[248:251], v[12:15], v[36:39]
    v_add_f32_dpp v82, v31, v82 row_ror:8 row_mask:0xf bank_mask:0x2
    v_mul_f32 v90, v90, v88
    v_mul_f32 v91, v91, v89
    v_exp_f32 v90, v90
    v_exp_f32 v91, v91
    v_add_f32 v90, 1.0, v90
    s_waitcnt vmcnt(4)
    s_mov_b32 s52, 0x123000
    buffer_load_dwordx4 a[104:107], v1, s[32:35], s52 offen offset:0 nt
    v_mfma_f32_16x16x32_bf16 v[36:39], a[252:255], v[16:19], v[36:39]
    v_mov_b32_dpp v82, v32 row_ror:8 row_mask:0xf bank_mask:0x4
    v_add_f32 v91, 1.0, v91
    v_rcp_f32 v90, v90
    v_rcp_f32 v91, v91
    v_mul_f32 v88, v88, v90
    v_mul_f32 v89, v89, v91
    s_waitcnt vmcnt(4)
    s_mov_b32 s52, 0x124000
    buffer_load_dwordx4 a[132:135], v1, s[32:35], s52 offen offset:0 nt
    s_mov_b32 s54, 0x1000
    buffer_load_dwordx4 v[132:135], v4, s[44:47], s54 offen
    s_cmp_eq_u32 s58, 28
    s_cbranch_scc0 L_skip34
    s_atomic_add s30, s[26:27], 0
L_skip34:
    v_mfma_f32_16x16x32_bf16 v[36:39], a[36:39], v[20:23], v[36:39]
    v_add_f32_dpp v82, v33, v82 row_ror:4 row_mask:0xf bank_mask:0x4
    v_cvt_pk_bf16_f32 v84, v88, v89
    v_lshlrev_b32 v88, 16, v84
    v_and_b32 v89, 0xffff0000, v84
    v_lshlrev_b32 v90, 16, v113
    v_and_b32 v91, 0xffff0000, v113
    s_waitcnt vmcnt(5)
    s_mov_b32 s52, 0x125000
    buffer_load_dwordx4 a[148:151], v1, s[32:35], s52 offen offset:0 nt
    v_mfma_f32_16x16x32_bf16 v[24:27], a[48:51], v[8:11], 0
    v_add_f32_dpp v82, v34, v82 quad_perm:[0,1,2,3] row_mask:0xf bank_mask:0x4
    v_fmac_f32 v121, v88, v90
    v_fmac_f32 v121, v89, v91
    v_lshlrev_b32 v88, 16, v98
    v_and_b32 v89, 0xffff0000, v98
    v_mul_f32 v88, v122, v88
    s_waitcnt vmcnt(5)
    s_mov_b32 s52, 0x126000
    buffer_load_dwordx4 a[160:163], v1, s[32:35], s52 offen offset:0 nt
    s_cmp_eq_u32 s58, 29
    s_cbranch_scc0 L_skip35
    s_atomic_add s30, s[26:27], 0
L_skip35:
    v_mfma_f32_16x16x32_bf16 v[24:27], a[64:67], v[12:15], v[24:27]
    v_add_f32_dpp v82, v35, v82 row_ror:12 row_mask:0xf bank_mask:0x4
    v_mul_f32 v89, v122, v89
    v_cvt_pk_bf16_f32 v84, v88, v89
    v_lshlrev_b32 v88, 16, v84
    v_and_b32 v89, 0xffff0000, v84
    v_lshlrev_b32 v90, 16, v106
    s_waitcnt vmcnt(5)
    s_mov_b32 s52, 0x127000
    buffer_load_dwordx4 a[188:191], v1, s[32:35], s52 offen offset:0 nt
    v_mfma_f32_16x16x32_bf16 v[24:27], a[92:95], v[16:19], v[24:27]
    v_mov_b32_dpp v82, v36 row_ror:12 row_mask:0xf bank_mask:0x8
    v_and_b32 v91, 0xffff0000, v106
    v_add_f32 v88, v88, v90
    v_add_f32 v89, v89, v91
    v_cvt_pk_bf16_f32 v84, v88, v89
    v_lshlrev_b32 v88, 16, v84
    s_waitcnt vmcnt(5)
    s_mov_b32 s52, 0x130000
    buffer_load_dwordx4 a[204:207], v1, s[32:35], s52 offen offset:0 nt
    s_cmp_eq_u32 s58, 30
    s_cbranch_scc0 L_skip36
    s_atomic_add s30, s[26:27], 0
L_skip36:
    v_mfma_f32_16x16x32_bf16 v[24:27], a[104:107], v[20:23], v[24:27]
    v_add_f32_dpp v82, v37, v82 row_ror:8 row_mask:0xf bank_mask:0x8
    v_and_b32 v89, 0xffff0000, v84
    v_mov_b32 v85, 0xc0135761
    v_mul_f32 v90, v88, v88
    v_mul_f32 v91, v89, v89
    v_fmamk_f32 v90, v90, 0xbdd2d3e8, v85
    s_waitcnt vmcnt(5)
    s_mov_b32 s52, 0x131000
    buffer_load_dwordx4 a[232:235], v1, s[32:35], s52 offen offset:0 nt
    v_mfma_f32_16x16x32_bf16 v[28:31], a[132:135], v[8:11], 0
    v_add_f32_dpp v82, v38, v82 row_ror:4 row_mask:0xf bank_mask:0x8
    v_fmamk_f32 v91, v91, 0xbdd2d3e8, v85
    v_mul_f32 v90, v90, v88
    v_mul_f32 v91, v91, v89
    v_exp_f32 v90, v90
    v_exp_f32 v91, v91
    s_waitcnt vmcnt(4)
    s_mov_b32 s52, 0x132000
    buffer_load_dwordx4 a[244:247], v1, s[32:35], s52 offen offset:0 nt
    s_cmp_eq_u32 s58, 31
    s_cbranch_scc0 L_skip37
    s_atomic_add s30, s[26:27], 0
L_skip37:
    v_mfma_f32_16x16x32_bf16 v[28:31], a[148:151], v[12:15], v[28:31]
    v_add_f32_dpp v82, v39, v82 quad_perm:[0,1,2,3] row_mask:0xf bank_mask:0x8
    v_cvt_pk_bf16_f32 v48, v82, v82
    v_and_b32 v48, 0xffff0000, v48
    v_mul_f32 v48, 0x3db504f3, v48
    v_cvt_pk_bf16_f32 v48, v48, v48
    v_and_b32 v48, 0xffff0000, v48
    v_max_f32 v80, v80, v48
    v_add_f32 v90, 1.0, v90
    v_add_f32 v91, 1.0, v91
    v_rcp_f32 v90, v90
    v_rcp_f32 v91, v91
    v_mul_f32 v88, v88, v90
    s_waitcnt vmcnt(4)
    s_mov_b32 s52, 0x133000
    buffer_load_dwordx4 a[20:23], v1, s[32:35], s52 offen offset:0 nt
    v_mfma_f32_16x16x32_bf16 v[28:31], a[160:163], v[16:19], v[28:31]
    v_mov_b32_dpp v83, v24 quad_perm:[0,1,2,3] row_mask:0xf bank_mask:0x1
    v_mul_f32 v89, v89, v91
    v_cvt_pk_bf16_f32 v84, v88, v89
    v_lshlrev_b32 v88, 16, v84
    v_and_b32 v89, 0xffff0000, v84
    v_lshlrev_b32 v90, 16, v114
    s_waitcnt vmcnt(4)
    s_mov_b32 s52, 0x134000
    buffer_load_dwordx4 a[76:79], v1, s[32:35], s52 offen offset:0 nt
    s_mov_b32 s54, 0x2000
    buffer_load_dwordx4 v[136:139], v4, s[44:47], s54 offen
    v_mfma_f32_16x16x32_bf16 v[28:31], a[188:191], v[20:23], v[28:31]
    v_add_f32_dpp v83, v25, v83 row_ror:12 row_mask:0xf bank_mask:0x1
    v_and_b32 v91, 0xffff0000, v114
    v_fmac_f32 v121, v88, v90
    v_fmac_f32 v121, v89, v91
    v_lshlrev_b32 v88, 16, v99
    v_and_b32 v89, 0xffff0000, v99
    s_waitcnt vmcnt(5)
    s_mov_b32 s52, 0x135000
    buffer_load_dwordx4 a[120:123], v1, s[32:35], s52 offen offset:0 nt
    v_mfma_f32_16x16x32_bf16 v[32:35], a[204:207], v[8:11], 0
    v_add_f32_dpp v83, v26, v83 row_ror:8 row_mask:0xf bank_mask:0x1
    v_mul_f32 v88, v122, v88
    v_mul_f32 v89, v122, v89
    v_cvt_pk_bf16_f32 v84, v88, v89
    v_lshlrev_b32 v88, 16, v84
    v_and_b32 v89, 0xffff0000, v84
    s_waitcnt vmcnt(5)
    s_mov_b32 s52, 0x136000
    buffer_load_dwordx4 a[176:179], v1, s[32:35], s52 offen offset:0 nt
    v_mfma_f32_16x16x32_bf16 v[32:35], a[232:235], v[12:15], v[32:35]
    v_add_f32_dpp v83, v27, v83 row_ror:4 row_mask:0xf bank_mask:0x1
    v_lshlrev_b32 v90, 16, v107
    v_and_b32 v91, 0xffff0000, v107
    v_add_f32 v88, v88, v90
    v_add_f32 v89, v89, v91
    v_cvt_pk_bf16_f32 v84, v88, v89
    s_waitcnt vmcnt(5)
    s_mov_b32 s52, 0x137000
    buffer_load_dwordx4 a[216:219], v1, s[32:35], s52 offen offset:0 nt
    v_mfma_f32_16x16x32_bf16 v[32:35], a[244:247], v[16:19], v[32:35]
    v_mov_b32_dpp v83, v28 row_ror:4 row_mask:0xf bank_mask:0x2
    v_lshlrev_b32 v88, 16, v84
    v_and_b32 v89, 0xffff0000, v84
    v_mov_b32 v85, 0xc0135761
    v_mul_f32 v90, v88, v88
    v_mul_f32 v91, v89, v89
    s_waitcnt vmcnt(5)
    s_mov_b32 s52, 0x140000
    buffer_load_dwordx4 a[0:3], v1, s[32:35], s52 offen offset:0 nt
    v_mfma_f32_16x16x32_bf16 v[32:35], a[20:23], v[20:23], v[32:35]
    v_add_f32_dpp v83, v29, v83 quad_perm:[0,1,2,3] row_mask:0xf bank_mask:0x2
    v_fmamk_f32 v90, v90, 0xbdd2d3e8, v85
    v_fmamk_f32 v91, v91, 0xbdd2d3e8, v85
    v_mul_f32 v90, v90, v88
    v_mul_f32 v91, v91, v89
    v_exp_f32 v90, v90
    s_waitcnt vmcnt(5)
    s_mov_b32 s52, 0x141000
    buffer_load_dwordx4 a[4:7], v1, s[32:35], s52 offen offset:0 nt
    v_mfma_f32_16x16x32_bf16 v[36:39], a[76:79], v[8:11], 0
    v_add_f32_dpp v83, v30, v83 row_ror:12 row_mask:0xf bank_mask:0x2
    v_exp_f32 v91, v91
    v_add_f32 v90, 1.0, v90
    v_add_f32 v91, 1.0, v91
    v_rcp_f32 v90, v90
    v_rcp_f32 v91, v91
    s_waitcnt vmcnt(4)
    s_mov_b32 s52, 0x142000
    buffer_load_dwordx4 a[8:11], v1, s[32:35], s52 offen offset:0 nt
    v_mfma_f32_16x16x32_bf16 v[36:39], a[120:123], v[12:15], v[36:39]
    v_add_f32_dpp v83, v31, v83 row_ror:8 row_mask:0xf bank_mask:0x2
    v_mul_f32 v88, v88, v90
    v_mul_f32 v89, v89, v91
    v_cvt_pk_bf16_f32 v84, v88, v89
    v_lshlrev_b32 v88, 16, v84
    v_and_b32 v89, 0xffff0000, v84
    s_waitcnt vmcnt(4)
    s_mov_b32 s52, 0x143000
    buffer_load_dwordx4 a[12:15], v1, s[32:35], s52 offen offset:0 nt
    v_mfma_f32_16x16x32_bf16 v[36:39], a[176:179], v[16:19], v[36:39]
    v_mov_b32_dpp v83, v32 row_ror:8 row_mask:0xf bank_mask:0x4
    v_lshlrev_b32 v90, 16, v115
    v_and_b32 v91, 0xffff0000, v115
    v_fmac_f32 v121, v88, v90
    v_fmac_f32 v121, v89, v91
    v_lshlrev_b32 v88, 16, v100
    s_waitcnt vmcnt(4)
    s_mov_b32 s52, 0x144000
    buffer_load_dwordx4 a[16:19], v1, s[32:35], s52 offen offset:0 nt
    s_mov_b32 s54, 0x3000
    buffer_load_dwordx4 v[140:143], v4, s[44:47], s54 offen
    v_mfma_f32_16x16x32_bf16 v[36:39], a[216:219], v[20:23], v[36:39]
    v_add_f32_dpp v83, v33, v83 row_ror:4 row_mask:0xf bank_mask:0x4
    v_and_b32 v89, 0xffff0000, v100
    v_mul_f32 v88, v122, v88
    v_mul_f32 v89, v122, v89
    v_cvt_pk_bf16_f32 v84, v88, v89
    v_lshlrev_b32 v88, 16, v84
    s_waitcnt vmcnt(5)
    s_mov_b32 s52, 0x145000
    buffer_load_dwordx4 a[24:27], v1, s[32:35], s52 offen offset:0 nt
    v_mfma_f32_16x16x32_bf16 v[24:27], a[0:3], v[8:11], 0
    v_add_f32_dpp v83, v34, v83 quad_perm:[0,1,2,3] row_mask:0xf bank_mask:0x4
    v_and_b32 v89, 0xffff0000, v84
    v_lshlrev_b32 v90, 16, v108
    v_and_b32 v91, 0xffff0000, v108
    v_add_f32 v88, v88, v90
    v_add_f32 v89, v89, v91
    s_waitcnt vmcnt(5)
    s_mov_b32 s52, 0x146000
    buffer_load_dwordx4 a[28:31], v1, s[32:35], s52 offen offset:0 nt
    v_mfma_f32_16x16x32_bf16 v[24:27], a[4:7], v[12:15], v[24:27]
    v_add_f32_dpp v83, v35, v83 row_ror:12 row_mask:0xf bank_mask:0x4
    v_cvt_pk_bf16_f32 v84, v88, v89
    v_lshlrev_b32 v88, 16, v84
    v_and_b32 v89, 0xffff0000, v84
    v_mov_b32 v85, 0xc0135761
    v_mul_f32 v90, v88, v88
    s_waitcnt vmcnt(5)
    s_mov_b32 s52, 0x147000
    buffer_load_dwordx4 a[32:35], v1, s[32:35], s52 offen offset:0 nt
    v_mfma_f32_16x16x32_bf16 v[24:27], a[8:11], v[16:19], v[24:27]
    v_mov_b32_dpp v83, v36 row_ror:12 row_mask:0xf bank_mask:0x8
    v_mul_f32 v91, v89, v89
    v_fmamk_f32 v90, v90, 0xbdd2d3e8, v85
    v_fmamk_f32 v91, v91, 0xbdd2d3e8, v85
    v_mul_f32 v90, v90, v88
    v_mul_f32 v91, v91, v89
    s_waitcnt vmcnt(5)
    s_mov_b32 s52, 0x150000
    buffer_load_dwordx4 a[40:43], v1, s[32:35], s52 offen offset:0 nt
    v_mfma_f32_16x16x32_bf16 v[24:27], a[12:15], v[20:23], v[24:27]
    v_add_f32_dpp v83, v37, v83 row_ror:8 row_mask:0xf bank_mask:0x8
    v_exp_f32 v90, v90
    v_exp_f32 v91, v91
    v_add_f32 v90, 1.0, v90
    v_add_f32 v91, 1.0, v91
    v_rcp_f32 v90, v90
    s_waitcnt vmcnt(5)
    s_mov_b32 s52, 0x151000
    buffer_load_dwordx4 a[44:47], v1, s[32:35], s52 offen offset:0 nt
    v_mfma_f32_16x16x32_bf16 v[28:31], a[16:19], v[8:11], 0
    v_add_f32_dpp v83, v38, v83 row_ror:4 row_mask:0xf bank_mask:0x8
    v_rcp_f32 v91, v91
    v_mul_f32 v88, v88, v90
    v_mul_f32 v89, v89, v91
    v_cvt_pk_bf16_f32 v84, v88, v89
    v_lshlrev_b32 v88, 16, v84
    s_waitcnt vmcnt(4)
    s_mov_b32 s52, 0x152000
    buffer_load_dwordx4 a[52:55], v1, s[32:35], s52 offen offset:0 nt
    v_mfma_f32_16x16x32_bf16 v[28:31], a[24:27], v[12:15], v[28:31]
    v_add_f32_dpp v83, v39, v83 quad_perm:[0,1,2,3] row_mask:0xf bank_mask:0x8
    v_cvt_pk_bf16_f32 v49, v83, v83
    v_and_b32 v49, 0xffff0000, v49
    v_mul_f32 v49, 0x3db504f3, v49
    v_cvt_pk_bf16_f32 v49, v49, v49
    v_and_b32 v49, 0xffff0000, v49
    v_max_f32 v80, v80, v49
    v_and_b32 v89, 0xffff0000, v84
    v_lshlrev_b32 v90, 16, v116
    v_and_b32 v91, 0xffff0000, v116
    v_fmac_f32 v121, v88, v90
    v_fmac_f32 v121, v89, v91
    s_waitcnt vmcnt(4)
    s_mov_b32 s52, 0x153000
    buffer_load_dwordx4 a[56:59], v1, s[32:35], s52 offen offset:0 nt
    v_mfma_f32_16x16x32_bf16 v[28:31], a[28:31], v[16:19], v[28:31]
    v_mov_b32_dpp v82, v24 quad_perm:[0,1,2,3] row_mask:0xf bank_mask:0x1
    v_lshlrev_b32 v88, 16, v101
    v_and_b32 v89, 0xffff0000, v101
    v_mul_f32 v88, v122, v88
    v_mul_f32 v89, v122, v89
    v_cvt_pk_bf16_f32 v84, v88, v89
    s_waitcnt vmcnt(4)
    s_mov_b32 s52, 0x154000
    buffer_load_dwordx4 a[60:63], v1, s[32:35], s52 offen offset:0 nt
    s_mov_b32 s54, 0x4000
    buffer_load_dwordx4 v[144:147], v4, s[44:47], s54 offen
    v_mfma_f32_16x16x32_bf16 v[28:31], a[32:35], v[20:23], v[28:31]
    v_add_f32_dpp v82, v25, v82 row_ror:12 row_mask:0xf bank_mask:0x1
    v_lshlrev_b32 v88, 16, v84
    v_and_b32 v89, 0xffff0000, v84
    v_lshlrev_b32 v90, 16, v109
    v_and_b32 v91, 0xffff0000, v109
    v_add_f32 v88, v88, v90
    s_waitcnt vmcnt(5)
    s_mov_b32 s52, 0x155000
    buffer_load_dwordx4 a[68:71], v1, s[32:35], s52 offen offset:0 nt
    v_mfma_f32_16x16x32_bf16 v[32:35], a[40:43], v[8:11], 0
    v_add_f32_dpp v82, v26, v82 row_ror:8 row_mask:0xf bank_mask:0x1
    v_add_f32 v89, v89, v91
    v_cvt_pk_bf16_f32 v84, v88, v89
    v_lshlrev_b32 v88, 16, v84
    v_and_b32 v89, 0xffff0000, v84
    v_mov_b32 v85, 0xc0135761
    s_waitcnt vmcnt(5)
    s_mov_b32 s52, 0x156000
    buffer_load_dwordx4 a[72:75], v1, s[32:35], s52 offen offset:0 nt
    v_mfma_f32_16x16x32_bf16 v[32:35], a[44:47], v[12:15], v[32:35]
    v_add_f32_dpp v82, v27, v82 row_ror:4 row_mask:0xf bank_mask:0x1
    v_mul_f32 v90, v88, v88
    v_mul_f32 v91, v89, v89
    v_fmamk_f32 v90, v90, 0xbdd2d3e8, v85
    v_fmamk_f32 v91, v91, 0xbdd2d3e8, v85
    v_mul_f32 v90, v90, v88
    s_waitcnt vmcnt(5)
    s_mov_b32 s52, 0x157000
    buffer_load_dwordx4 a[80:83], v1, s[32:35], s52 offen offset:0 nt
    v_mfma_f32_16x16x32_bf16 v[32:35], a[52:55], v[16:19], v[32:35]
    v_mov_b32_dpp v82, v28 row_ror:4 row_mask:0xf bank_mask:0x2
    v_mul_f32 v91, v91, v89
    v_exp_f32 v90, v90
    v_exp_f32 v91, v91
    v_add_f32 v90, 1.0, v90
    v_add_f32 v91, 1.0, v91
    s_waitcnt vmcnt(5)
    s_mov_b32 s52, 0x160000
    buffer_load_dwordx4 a[84:87], v1, s[32:35], s52 offen offset:0 nt
    v_mfma_f32_16x16x32_bf16 v[32:35], a[56:59], v[20:23], v[32:35]
    v_add_f32_dpp v82, v29, v82 quad_perm:[0,1,2,3] row_mask:0xf bank_mask:0x2
    v_rcp_f32 v90, v90
    v_rcp_f32 v91, v91
    v_mul_f32 v88, v88, v90
    v_mul_f32 v89, v89, v91
    v_cvt_pk_bf16_f32 v84, v88, v89
    s_waitcnt vmcnt(5)
    s_mov_b32 s52, 0x161000
    buffer_load_dwordx4 a[88:91], v1, s[32:35], s52 offen offset:0 nt
    v_mfma_f32_16x16x32_bf16 v[36:39], a[60:63], v[8:11], 0
    v_add_f32_dpp v82, v30, v82 row_ror:12 row_mask:0xf bank_mask:0x2
    v_lshlrev_b32 v88, 16, v84
    v_and_b32 v89, 0xffff0000, v84
    v_lshlrev_b32 v90, 16, v117
    v_and_b32 v91, 0xffff0000, v117
    v_fmac_f32 v121, v88, v90
    s_waitcnt vmcnt(4)
    s_mov_b32 s52, 0x162000
    buffer_load_dwordx4 a[96:99], v1, s[32:35], s52 offen offset:0 nt
    v_mfma_f32_16x16x32_bf16 v[36:39], a[68:71], v[12:15], v[36:39]
    v_add_f32_dpp v82, v31, v82 row_ror:8 row_mask:0xf bank_mask:0x2
    v_fmac_f32 v121, v89, v91
    v_lshlrev_b32 v88, 16, v102
    v_and_b32 v89, 0xffff0000, v102
    v_mul_f32 v88, v122, v88
    v_mul_f32 v89, v122, v89
    s_waitcnt vmcnt(4)
    s_mov_b32 s52, 0x163000
    buffer_load_dwordx4 a[100:103], v1, s[32:35], s52 offen offset:0 nt
    v_mfma_f32_16x16x32_bf16 v[36:39], a[72:75], v[16:19], v[36:39]
    v_mov_b32_dpp v82, v32 row_ror:8 row_mask:0xf bank_mask:0x4
    v_cvt_pk_bf16_f32 v84, v88, v89
    v_lshlrev_b32 v88, 16, v84
    v_and_b32 v89, 0xffff0000, v84
    v_lshlrev_b32 v90, 16, v110
    v_and_b32 v91, 0xffff0000, v110
    s_waitcnt vmcnt(4)
    s_mov_b32 s52, 0x164000
    buffer_load_dwordx4 a[108:111], v1, s[32:35], s52 offen offset:0 nt
    s_mov_b32 s54, 0x5000
    buffer_load_dwordx4 v[148:151], v4, s[44:47], s54 offen
    v_mfma_f32_16x16x32_bf16 v[36:39], a[80:83], v[20:23], v[36:39]
    v_add_f32_dpp v82, v33, v82 row_ror:4 row_mask:0xf bank_mask:0x4
    v_add_f32 v88, v88, v90
    v_add_f32 v89, v89, v91
    v_cvt_pk_bf16_f32 v84, v88, v89
    v_lshlrev_b32 v88, 16, v84
    v_and_b32 v89, 0xffff0000, v84
    s_waitcnt vmcnt(5)
    s_mov_b32 s52, 0x165000
    buffer_load_dwordx4 a[112:115], v1, s[32:35], s52 offen offset:0 nt
    v_mfma_f32_16x16x32_bf16 v[24:27], a[84:87], v[8:11], 0
    v_add_f32_dpp v82, v34, v82 quad_perm:[0,1,2,3] row_mask:0xf bank_mask:0x4
    v_mov_b32 v85, 0xc0135761
    v_mul_f32 v90, v88, v88
    v_mul_f32 v91, v89, v89
    v_fmamk_f32 v90, v90, 0xbdd2d3e8, v85
    v_fmamk_f32 v91, v91, 0xbdd2d3e8, v85
    s_waitcnt vmcnt(5)
    s_mov_b32 s52, 0x166000
    buffer_load_dwordx4 a[116:119], v1, s[32:35], s52 offen offset:0 nt
    v_mfma_f32_16x16x32_bf16 v[24:27], a[88:91], v[12:15], v[24:27]
    v_add_f32_dpp v82, v35, v82 row_ror:12 row_mask:0xf bank_mask:0x4
    v_mul_f32 v90, v90, v88
    v_mul_f32 v91, v91, v89
    v_exp_f32 v90, v90
    v_exp_f32 v91, v91
    v_add_f32 v90, 1.0, v90
    s_waitcnt vmcnt(5)
    s_mov_b32 s52, 0x167000
    buffer_load_dwordx4 a[124:127], v1, s[32:35], s52 offen offset:0 nt
    v_mfma_f32_16x16x32_bf16 v[24:27], a[96:99], v[16:19], v[24:27]
    v_mov_b32_dpp v82, v36 row_ror:12 row_mask:0xf bank_mask:0x8
    v_add_f32 v91, 1.0, v91
    v_rcp_f32 v90, v90
    v_rcp_f32 v91, v91
    v_mul_f32 v88, v88, v90
    v_mul_f32 v89, v89, v91
    s_waitcnt vmcnt(5)
    s_mov_b32 s52, 0x170000
    buffer_load_dwordx4 a[128:131], v1, s[32:35], s52 offen offset:0 nt
    v_mfma_f32_16x16x32_bf16 v[24:27], a[100:103], v[20:23], v[24:27]
    v_add_f32_dpp v82, v37, v82 row_ror:8 row_mask:0xf bank_mask:0x8
    v_cvt_pk_bf16_f32 v84, v88, v89
    v_lshlrev_b32 v88, 16, v84
    v_and_b32 v89, 0xffff0000, v84
    v_lshlrev_b32 v90, 16, v118
    v_and_b32 v91, 0xffff0000, v118
    s_waitcnt vmcnt(5)
    s_mov_b32 s52, 0x171000
    buffer_load_dwordx4 a[136:139], v1, s[32:35], s52 offen offset:0 nt
    v_mfma_f32_16x16x32_bf16 v[28:31], a[108:111], v[8:11], 0
    v_add_f32_dpp v82, v38, v82 row_ror:4 row_mask:0xf bank_mask:0x8
    v_fmac_f32 v121, v88, v90
    v_fmac_f32 v121, v89, v91
    s_nop 1
    v_add_f32_dpp v121, v121, v121 quad_perm:[1,0,3,2] row_mask:0xf bank_mask:0xf
    s_nop 1
    v_add_f32_dpp v121, v121, v121 quad_perm:[2,3,0,1] row_mask:0xf bank_mask:0xf
    s_nop 1
    v_add_f32_dpp v121, v121, v121 row_half_mirror row_mask:0xf bank_mask:0xf
    s_waitcnt vmcnt(4)
    s_mov_b32 s52, 0x172000
    buffer_load_dwordx4 a[140:143], v1, s[32:35], s52 offen offset:0 nt
    v_mfma_f32_16x16x32_bf16 v[28:31], a[112:115], v[12:15], v[28:31]
    v_add_f32_dpp v82, v39, v82 quad_perm:[0,1,2,3] row_mask:0xf bank_mask:0x8
    v_cvt_pk_bf16_f32 v50, v82, v82
    v_and_b32 v50, 0xffff0000, v50
    v_mul_f32 v50, 0x3db504f3, v50
    v_cvt_pk_bf16_f32 v50, v50, v50
    v_and_b32 v50, 0xffff0000, v50
    v_max_f32 v80, v80, v50
    v_add_f32_dpp v121, v121, v121 row_mirror row_mask:0xf bank_mask:0xf
    v_mov_b32 v84, v121
    s_nop 1
    v_permlane16_swap_b32 v121, v84
    v_add_f32 v121, v121, v84
    v_mov_b32 v84, v121
    s_waitcnt vmcnt(4)
    s_mov_b32 s52, 0x173000
    buffer_load_dwordx4 a[144:147], v1, s[32:35], s52 offen offset:0 nt
    v_mfma_f32_16x16x32_bf16 v[28:31], a[116:119], v[16:19], v[28:31]
    v_mov_b32_dpp v83, v24 quad_perm:[0,1,2,3] row_mask:0xf bank_mask:0x1
    v_permlane32_swap_b32 v121, v84
    v_add_f32 v121, v121, v84
    s_waitcnt vmcnt(4)
    s_mov_b32 s52, 0x174000
    buffer_load_dwordx4 a[152:155], v1, s[32:35], s52 offen offset:0 nt
    s_mov_b32 s54, 0x6000
    buffer_load_dwordx4 v[152:155], v4, s[44:47], s54 offen
    v_mfma_f32_16x16x32_bf16 v[28:31], a[124:127], v[20:23], v[28:31]
    v_add_f32_dpp v83, v25, v83 row_ror:12 row_mask:0xf bank_mask:0x1
    s_waitcnt vmcnt(5)
    s_mov_b32 s52, 0x175000
    buffer_load_dwordx4 a[156:159], v1, s[32:35], s52 offen offset:0 nt
    v_mfma_f32_16x16x32_bf16 v[32:35], a[128:131], v[8:11], 0
    v_add_f32_dpp v83, v26, v83 row_ror:8 row_mask:0xf bank_mask:0x1
    s_waitcnt vmcnt(5)
    s_mov_b32 s52, 0x176000
    buffer_load_dwordx4 a[164:167], v1, s[32:35], s52 offen offset:0 nt
    v_mfma_f32_16x16x32_bf16 v[32:35], a[136:139], v[12:15], v[32:35]
    v_add_f32_dpp v83, v27, v83 row_ror:4 row_mask:0xf bank_mask:0x1
    s_waitcnt vmcnt(5)
    s_mov_b32 s52, 0x177000
    buffer_load_dwordx4 a[168:171], v1, s[32:35], s52 offen offset:0 nt
    v_mfma_f32_16x16x32_bf16 v[32:35], a[140:143], v[16:19], v[32:35]
    v_mov_b32_dpp v83, v28 row_ror:4 row_mask:0xf bank_mask:0x2
    s_waitcnt vmcnt(5)
    s_mov_b32 s52, 0x180000
    buffer_load_dwordx4 a[172:175], v1, s[32:35], s52 offen offset:0 nt
    v_mfma_f32_16x16x32_bf16 v[32:35], a[144:147], v[20:23], v[32:35]
    v_add_f32_dpp v83, v29, v83 quad_perm:[0,1,2,3] row_mask:0xf bank_mask:0x2
    s_waitcnt vmcnt(5)
    s_mov_b32 s52, 0x181000
    buffer_load_dwordx4 a[180:183], v1, s[32:35], s52 offen offset:0 nt
    v_mfma_f32_16x16x32_bf16 v[36:39], a[152:155], v[8:11], 0
    v_add_f32_dpp v83, v30, v83 row_ror:12 row_mask:0xf bank_mask:0x2
    s_waitcnt vmcnt(4)
    s_mov_b32 s52, 0x182000
    buffer_load_dwordx4 a[184:187], v1, s[32:35], s52 offen offset:0 nt
    v_mfma_f32_16x16x32_bf16 v[36:39], a[156:159], v[12:15], v[36:39]
    v_add_f32_dpp v83, v31, v83 row_ror:8 row_mask:0xf bank_mask:0x2
    s_waitcnt vmcnt(4)
    s_mov_b32 s52, 0x183000
    buffer_load_dwordx4 a[192:195], v1, s[32:35], s52 offen offset:0 nt
    v_mfma_f32_16x16x32_bf16 v[36:39], a[164:167], v[16:19], v[36:39]
    v_mov_b32_dpp v83, v32 row_ror:8 row_mask:0xf bank_mask:0x4
    s_waitcnt vmcnt(4)
    s_mov_b32 s52, 0x184000
    buffer_load_dwordx4 a[196:199], v1, s[32:35], s52 offen offset:0 nt
    s_mov_b32 s54, 0x7000
    buffer_load_dwordx4 v[156:159], v4, s[44:47], s54 offen
    v_mfma_f32_16x16x32_bf16 v[36:39], a[168:171], v[20:23], v[36:39]
    v_add_f32_dpp v83, v33, v83 row_ror:4 row_mask:0xf bank_mask:0x4
    s_waitcnt vmcnt(5)
    s_mov_b32 s52, 0x185000
    buffer_load_dwordx4 a[200:203], v1, s[32:35], s52 offen offset:0 nt
    v_mfma_f32_16x16x32_bf16 v[24:27], a[172:175], v[8:11], 0
    v_add_f32_dpp v83, v34, v83 quad_perm:[0,1,2,3] row_mask:0xf bank_mask:0x4
    s_waitcnt vmcnt(5)
    s_mov_b32 s52, 0x186000
    buffer_load_dwordx4 a[208:211], v1, s[32:35], s52 offen offset:0 nt
    v_mfma_f32_16x16x32_bf16 v[24:27], a[180:183], v[12:15], v[24:27]
    v_add_f32_dpp v83, v35, v83 row_ror:12 row_mask:0xf bank_mask:0x4
    s_waitcnt vmcnt(5)
    s_mov_b32 s52, 0x187000
    buffer_load_dwordx4 a[212:215], v1, s[32:35], s52 offen offset:0 nt
    v_mfma_f32_16x16x32_bf16 v[24:27], a[184:187], v[16:19], v[24:27]
    v_mov_b32_dpp v83, v36 row_ror:12 row_mask:0xf bank_mask:0x8
    s_waitcnt vmcnt(5)
    s_mov_b32 s52, 0x190000
    buffer_load_dwordx4 a[220:223], v1, s[32:35], s52 offen offset:0 nt
    v_mfma_f32_16x16x32_bf16 v[24:27], a[192:195], v[20:23], v[24:27]
    v_add_f32_dpp v83, v37, v83 row_ror:8 row_mask:0xf bank_mask:0x8
    s_waitcnt vmcnt(5)
    s_mov_b32 s52, 0x191000
    buffer_load_dwordx4 a[224:227], v1, s[32:35], s52 offen offset:0 nt
    v_mfma_f32_16x16x32_bf16 v[28:31], a[196:199], v[8:11], 0
    v_add_f32_dpp v83, v38, v83 row_ror:4 row_mask:0xf bank_mask:0x8
    s_waitcnt vmcnt(4)
    s_mov_b32 s52, 0x192000
    buffer_load_dwordx4 a[228:231], v1, s[32:35], s52 offen offset:0 nt
    v_mfma_f32_16x16x32_bf16 v[28:31], a[200:203], v[12:15], v[28:31]
    v_add_f32_dpp v83, v39, v83 quad_perm:[0,1,2,3] row_mask:0xf bank_mask:0x8
    v_cvt_pk_bf16_f32 v51, v83, v83
    v_and_b32 v51, 0xffff0000, v51
    v_mul_f32 v51, 0x3db504f3, v51
    v_cvt_pk_bf16_f32 v51, v51, v51
    v_and_b32 v51, 0xffff0000, v51
    v_max_f32 v80, v80, v51
    s_waitcnt vmcnt(4)
    s_mov_b32 s52, 0x193000
    buffer_load_dwordx4 a[236:239], v1, s[32:35], s52 offen offset:0 nt
    v_mfma_f32_16x16x32_bf16 v[28:31], a[208:211], v[16:19], v[28:31]
    v_mov_b32_dpp v82, v24 quad_perm:[0,1,2,3] row_mask:0xf bank_mask:0x1
    s_waitcnt vmcnt(4)
    s_mov_b32 s52, 0x194000
    buffer_load_dwordx4 a[240:243], v1, s[32:35], s52 offen offset:0 nt
    s_mov_b32 s54, 0x8000
    buffer_load_dwordx4 v[160:163], v4, s[44:47], s54 offen
    v_mfma_f32_16x16x32_bf16 v[28:31], a[212:215], v[20:23], v[28:31]
    v_add_f32_dpp v82, v25, v82 row_ror:12 row_mask:0xf bank_mask:0x1
    s_waitcnt vmcnt(5)
    s_mov_b32 s52, 0x195000
    buffer_load_dwordx4 a[248:251], v1, s[32:35], s52 offen offset:0 nt
    v_mfma_f32_16x16x32_bf16 v[32:35], a[220:223], v[8:11], 0
    v_add_f32_dpp v82, v26, v82 row_ror:8 row_mask:0xf bank_mask:0x1
    s_waitcnt vmcnt(5)
    s_mov_b32 s52, 0x196000
    buffer_load_dwordx4 a[252:255], v1, s[32:35], s52 offen offset:0 nt
    v_mfma_f32_16x16x32_bf16 v[32:35], a[224:227], v[12:15], v[32:35]
    v_add_f32_dpp v82, v27, v82 row_ror:4 row_mask:0xf bank_mask:0x1
    s_waitcnt vmcnt(5)
    s_mov_b32 s52, 0x197000
    buffer_load_dwordx4 a[36:39], v1, s[32:35], s52 offen offset:0 nt
    v_mfma_f32_16x16x32_bf16 v[32:35], a[228:231], v[16:19], v[32:35]
    v_mov_b32_dpp v82, v28 row_ror:4 row_mask:0xf bank_mask:0x2
    s_waitcnt vmcnt(5)
    s_mov_b32 s52, 0x1a0000
    buffer_load_dwordx4 a[48:51], v1, s[32:35], s52 offen offset:0 nt
    v_mfma_f32_16x16x32_bf16 v[32:35], a[236:239], v[20:23], v[32:35]
    v_add_f32_dpp v82, v29, v82 quad_perm:[0,1,2,3] row_mask:0xf bank_mask:0x2
    s_waitcnt vmcnt(5)
    s_mov_b32 s52, 0x1a1000
    buffer_load_dwordx4 a[64:67], v1, s[32:35], s52 offen offset:0 nt
    v_mfma_f32_16x16x32_bf16 v[36:39], a[240:243], v[8:11], 0
    v_add_f32_dpp v82, v30, v82 row_ror:12 row_mask:0xf bank_mask:0x2
    s_waitcnt vmcnt(4)
    s_mov_b32 s52, 0x1a2000
    buffer_load_dwordx4 a[92:95], v1, s[32:35], s52 offen offset:0 nt
    v_mfma_f32_16x16x32_bf16 v[36:39], a[248:251], v[12:15], v[36:39]
    v_add_f32_dpp v82, v31, v82 row_ror:8 row_mask:0xf bank_mask:0x2
    s_waitcnt vmcnt(4)
    s_mov_b32 s52, 0x1a3000
    buffer_load_dwordx4 a[104:107], v1, s[32:35], s52 offen offset:0 nt
    v_mfma_f32_16x16x32_bf16 v[36:39], a[252:255], v[16:19], v[36:39]
    v_mov_b32_dpp v82, v32 row_ror:8 row_mask:0xf bank_mask:0x4
    s_waitcnt vmcnt(4)
    s_mov_b32 s52, 0x1a4000
    buffer_load_dwordx4 a[132:135], v1, s[32:35], s52 offen offset:0 nt
    s_mov_b32 s54, 0x9000
    buffer_load_dwordx4 v[164:167], v4, s[44:47], s54 offen
    v_mfma_f32_16x16x32_bf16 v[36:39], a[36:39], v[20:23], v[36:39]
    v_add_f32_dpp v82, v33, v82 row_ror:4 row_mask:0xf bank_mask:0x4
    s_waitcnt vmcnt(5)
    s_mov_b32 s52, 0x1a5000
    buffer_load_dwordx4 a[148:151], v1, s[32:35], s52 offen offset:0 nt
    v_mfma_f32_16x16x32_bf16 v[24:27], a[48:51], v[8:11], 0
    v_add_f32_dpp v82, v34, v82 quad_perm:[0,1,2,3] row_mask:0xf bank_mask:0x4
    s_waitcnt vmcnt(5)
    s_mov_b32 s52, 0x1a6000
    buffer_load_dwordx4 a[160:163], v1, s[32:35], s52 offen offset:0 nt
    v_mfma_f32_16x16x32_bf16 v[24:27], a[64:67], v[12:15], v[24:27]
    v_add_f32_dpp v82, v35, v82 row_ror:12 row_mask:0xf bank_mask:0x4
    s_waitcnt vmcnt(5)
    s_mov_b32 s52, 0x1a7000
    buffer_load_dwordx4 a[188:191], v1, s[32:35], s52 offen offset:0 nt
    v_mfma_f32_16x16x32_bf16 v[24:27], a[92:95], v[16:19], v[24:27]
    v_mov_b32_dpp v82, v36 row_ror:12 row_mask:0xf bank_mask:0x8
    s_waitcnt vmcnt(5)
    s_mov_b32 s52, 0x1b0000
    buffer_load_dwordx4 a[204:207], v1, s[32:35], s52 offen offset:0 nt
    v_mfma_f32_16x16x32_bf16 v[24:27], a[104:107], v[20:23], v[24:27]
    v_add_f32_dpp v82, v37, v82 row_ror:8 row_mask:0xf bank_mask:0x8
    s_waitcnt vmcnt(5)
    s_mov_b32 s52, 0x1b1000
    buffer_load_dwordx4 a[232:235], v1, s[32:35], s52 offen offset:0 nt
    v_mfma_f32_16x16x32_bf16 v[28:31], a[132:135], v[8:11], 0
    v_add_f32_dpp v82, v38, v82 row_ror:4 row_mask:0xf bank_mask:0x8
    s_waitcnt vmcnt(4)
    s_mov_b32 s52, 0x1b2000
    buffer_load_dwordx4 a[244:247], v1, s[32:35], s52 offen offset:0 nt
    v_mfma_f32_16x16x32_bf16 v[28:31], a[148:151], v[12:15], v[28:31]
    v_add_f32_dpp v82, v39, v82 quad_perm:[0,1,2,3] row_mask:0xf bank_mask:0x8
    v_cvt_pk_bf16_f32 v52, v82, v82
    v_and_b32 v52, 0xffff0000, v52
    v_mul_f32 v52, 0x3db504f3, v52
    v_cvt_pk_bf16_f32 v52, v52, v52
    v_and_b32 v52, 0xffff0000, v52
    v_max_f32 v80, v80, v52
    s_waitcnt vmcnt(4)
    s_mov_b32 s52, 0x1b3000
    buffer_load_dwordx4 a[20:23], v1, s[32:35], s52 offen offset:0 nt
    v_mfma_f32_16x16x32_bf16 v[28:31], a[160:163], v[16:19], v[28:31]
    v_mov_b32_dpp v83, v24 quad_perm:[0,1,2,3] row_mask:0xf bank_mask:0x1
    s_waitcnt vmcnt(4)
    s_mov_b32 s52, 0x1b4000
    buffer_load_dwordx4 a[76:79], v1, s[32:35], s52 offen offset:0 nt
    s_mov_b32 s54, 0xa000
    buffer_load_dwordx4 v[168:171], v4, s[44:47], s54 offen
    v_mfma_f32_16x16x32_bf16 v[28:31], a[188:191], v[20:23], v[28:31]
    v_add_f32_dpp v83, v25, v83 row_ror:12 row_mask:0xf bank_mask:0x1
    s_waitcnt vmcnt(5)
    s_mov_b32 s52, 0x1b5000
    buffer_load_dwordx4 a[120:123], v1, s[32:35], s52 offen offset:0 nt
    v_mfma_f32_16x16x32_bf16 v[32:35], a[204:207], v[8:11], 0
    v_add_f32_dpp v83, v26, v83 row_ror:8 row_mask:0xf bank_mask:0x1
    s_waitcnt vmcnt(5)
    s_mov_b32 s52, 0x1b6000
    buffer_load_dwordx4 a[176:179], v1, s[32:35], s52 offen offset:0 nt
    v_mfma_f32_16x16x32_bf16 v[32:35], a[232:235], v[12:15], v[32:35]
    v_add_f32_dpp v83, v27, v83 row_ror:4 row_mask:0xf bank_mask:0x1
    s_waitcnt vmcnt(5)
    s_mov_b32 s52, 0x1b7000
    buffer_load_dwordx4 a[216:219], v1, s[32:35], s52 offen offset:0 nt
    v_mfma_f32_16x16x32_bf16 v[32:35], a[244:247], v[16:19], v[32:35]
    v_mov_b32_dpp v83, v28 row_ror:4 row_mask:0xf bank_mask:0x2
    s_waitcnt vmcnt(5)
    s_mov_b32 s52, 0x1c0000
    buffer_load_dwordx4 a[0:3], v1, s[32:35], s52 offen offset:0 nt
    v_mfma_f32_16x16x32_bf16 v[32:35], a[20:23], v[20:23], v[32:35]
    v_add_f32_dpp v83, v29, v83 quad_perm:[0,1,2,3] row_mask:0xf bank_mask:0x2
    s_waitcnt vmcnt(5)
    s_mov_b32 s52, 0x1c1000
    buffer_load_dwordx4 a[4:7], v1, s[32:35], s52 offen offset:0 nt
    v_mfma_f32_16x16x32_bf16 v[36:39], a[76:79], v[8:11], 0
    v_add_f32_dpp v83, v30, v83 row_ror:12 row_mask:0xf bank_mask:0x2
    s_waitcnt vmcnt(4)
    s_mov_b32 s52, 0x1c2000
    buffer_load_dwordx4 a[8:11], v1, s[32:35], s52 offen offset:0 nt
    v_mfma_f32_16x16x32_bf16 v[36:39], a[120:123], v[12:15], v[36:39]
    v_add_f32_dpp v83, v31, v83 row_ror:8 row_mask:0xf bank_mask:0x2
    s_waitcnt vmcnt(4)
    s_mov_b32 s52, 0x1c3000
    buffer_load_dwordx4 a[12:15], v1, s[32:35], s52 offen offset:0 nt
    v_mfma_f32_16x16x32_bf16 v[36:39], a[176:179], v[16:19], v[36:39]
    v_mov_b32_dpp v83, v32 row_ror:8 row_mask:0xf bank_mask:0x4
    s_waitcnt vmcnt(4)
    s_mov_b32 s52, 0x1c4000
    buffer_load_dwordx4 a[16:19], v1, s[32:35], s52 offen offset:0 nt
    s_mov_b32 s54, 0xb000
    buffer_load_dwordx4 v[172:175], v4, s[44:47], s54 offen
    v_mfma_f32_16x16x32_bf16 v[36:39], a[216:219], v[20:23], v[36:39]
    v_add_f32_dpp v83, v33, v83 row_ror:4 row_mask:0xf bank_mask:0x4
    s_waitcnt vmcnt(5)
    s_mov_b32 s52, 0x1c5000
    buffer_load_dwordx4 a[24:27], v1, s[32:35], s52 offen offset:0 nt
    v_mfma_f32_16x16x32_bf16 v[24:27], a[0:3], v[8:11], 0
    v_add_f32_dpp v83, v34, v83 quad_perm:[0,1,2,3] row_mask:0xf bank_mask:0x4
    s_waitcnt vmcnt(5)
    s_mov_b32 s52, 0x1c6000
    buffer_load_dwordx4 a[28:31], v1, s[32:35], s52 offen offset:0 nt
    v_mfma_f32_16x16x32_bf16 v[24:27], a[4:7], v[12:15], v[24:27]
    v_add_f32_dpp v83, v35, v83 row_ror:12 row_mask:0xf bank_mask:0x4
    s_waitcnt vmcnt(5)
    s_mov_b32 s52, 0x1c7000
    buffer_load_dwordx4 a[32:35], v1, s[32:35], s52 offen offset:0 nt
    v_mfma_f32_16x16x32_bf16 v[24:27], a[8:11], v[16:19], v[24:27]
    v_mov_b32_dpp v83, v36 row_ror:12 row_mask:0xf bank_mask:0x8
    s_waitcnt vmcnt(5)
    s_mov_b32 s52, 0x1d0000
    buffer_load_dwordx4 a[40:43], v1, s[32:35], s52 offen offset:0 nt
    v_mfma_f32_16x16x32_bf16 v[24:27], a[12:15], v[20:23], v[24:27]
    v_add_f32_dpp v83, v37, v83 row_ror:8 row_mask:0xf bank_mask:0x8
    s_waitcnt vmcnt(5)
    s_mov_b32 s52, 0x1d1000
    buffer_load_dwordx4 a[44:47], v1, s[32:35], s52 offen offset:0 nt
    v_mfma_f32_16x16x32_bf16 v[28:31], a[16:19], v[8:11], 0
    v_add_f32_dpp v83, v38, v83 row_ror:4 row_mask:0xf bank_mask:0x8
    s_waitcnt vmcnt(4)
    s_mov_b32 s52, 0x1d2000
    buffer_load_dwordx4 a[52:55], v1, s[32:35], s52 offen offset:0 nt
    v_mfma_f32_16x16x32_bf16 v[28:31], a[24:27], v[12:15], v[28:31]
    v_add_f32_dpp v83, v39, v83 quad_perm:[0,1,2,3] row_mask:0xf bank_mask:0x8
    v_cvt_pk_bf16_f32 v53, v83, v83
    v_and_b32 v53, 0xffff0000, v53
    v_mul_f32 v53, 0x3db504f3, v53
    v_cvt_pk_bf16_f32 v53, v53, v53
    v_and_b32 v53, 0xffff0000, v53
    v_max_f32 v80, v80, v53
    s_waitcnt vmcnt(4)
    s_mov_b32 s52, 0x1d3000
    buffer_load_dwordx4 a[56:59], v1, s[32:35], s52 offen offset:0 nt
    v_mfma_f32_16x16x32_bf16 v[28:31], a[28:31], v[16:19], v[28:31]
    v_mov_b32_dpp v82, v24 quad_perm:[0,1,2,3] row_mask:0xf bank_mask:0x1
    s_waitcnt vmcnt(4)
    s_mov_b32 s52, 0x1d4000
    buffer_load_dwordx4 a[60:63], v1, s[32:35], s52 offen offset:0 nt
    s_mov_b32 s54, 0xc000
    buffer_load_dwordx4 v[176:179], v4, s[44:47], s54 offen
    s_load_dword s59, s[26:27], 0
    v_mfma_f32_16x16x32_bf16 v[28:31], a[32:35], v[20:23], v[28:31]
    v_add_f32_dpp v82, v25, v82 row_ror:12 row_mask:0xf bank_mask:0x1
    s_waitcnt vmcnt(5)
    s_mov_b32 s52, 0x1d5000
    buffer_load_dwordx4 a[68:71], v1, s[32:35], s52 offen offset:0 nt
    v_mfma_f32_16x16x32_bf16 v[32:35], a[40:43], v[8:11], 0
    v_add_f32_dpp v82, v26, v82 row_ror:8 row_mask:0xf bank_mask:0x1
    s_waitcnt vmcnt(5)
    s_mov_b32 s52, 0x1d6000
    buffer_load_dwordx4 a[72:75], v1, s[32:35], s52 offen offset:0 nt
    v_mfma_f32_16x16x32_bf16 v[32:35], a[44:47], v[12:15], v[32:35]
    v_add_f32_dpp v82, v27, v82 row_ror:4 row_mask:0xf bank_mask:0x1
    s_waitcnt vmcnt(5)
    s_mov_b32 s52, 0x1d7000
    buffer_load_dwordx4 a[80:83], v1, s[32:35], s52 offen offset:0 nt
    v_mfma_f32_16x16x32_bf16 v[32:35], a[52:55], v[16:19], v[32:35]
    v_mov_b32_dpp v82, v28 row_ror:4 row_mask:0xf bank_mask:0x2
    s_waitcnt vmcnt(5)
    s_mov_b32 s52, 0x1e0000
    buffer_load_dwordx4 a[84:87], v1, s[32:35], s52 offen offset:0 nt
    v_mfma_f32_16x16x32_bf16 v[32:35], a[56:59], v[20:23], v[32:35]
    v_add_f32_dpp v82, v29, v82 quad_perm:[0,1,2,3] row_mask:0xf bank_mask:0x2
    s_waitcnt vmcnt(5)
    s_mov_b32 s52, 0x1e1000
    buffer_load_dwordx4 a[88:91], v1, s[32:35], s52 offen offset:0 nt
    v_mfma_f32_16x16x32_bf16 v[36:39], a[60:63], v[8:11], 0
    v_add_f32_dpp v82, v30, v82 row_ror:12 row_mask:0xf bank_mask:0x2
    s_waitcnt vmcnt(4)
    s_mov_b32 s52, 0x1e2000
    buffer_load_dwordx4 a[96:99], v1, s[32:35], s52 offen offset:0 nt
    v_mfma_f32_16x16x32_bf16 v[36:39], a[68:71], v[12:15], v[36:39]
    v_add_f32_dpp v82, v31, v82 row_ror:8 row_mask:0xf bank_mask:0x2
    s_waitcnt vmcnt(4)
    s_mov_b32 s52, 0x1e3000
    buffer_load_dwordx4 a[100:103], v1, s[32:35], s52 offen offset:0 nt
    v_mfma_f32_16x16x32_bf16 v[36:39], a[72:75], v[16:19], v[36:39]
    v_mov_b32_dpp v82, v32 row_ror:8 row_mask:0xf bank_mask:0x4
    s_waitcnt vmcnt(4)
    s_mov_b32 s52, 0x1e4000
    buffer_load_dwordx4 a[108:111], v1, s[32:35], s52 offen offset:0 nt
    s_mov_b32 s54, 0xd000
    buffer_load_dwordx4 v[180:183], v4, s[44:47], s54 offen
    v_mfma_f32_16x16x32_bf16 v[36:39], a[80:83], v[20:23], v[36:39]
    v_add_f32_dpp v82, v33, v82 row_ror:4 row_mask:0xf bank_mask:0x4
    s_waitcnt vmcnt(5)
    s_mov_b32 s52, 0x1e5000
    buffer_load_dwordx4 a[112:115], v1, s[32:35], s52 offen offset:0 nt
    v_mfma_f32_16x16x32_bf16 v[24:27], a[84:87], v[8:11], 0
    v_add_f32_dpp v82, v34, v82 quad_perm:[0,1,2,3] row_mask:0xf bank_mask:0x4
    s_waitcnt vmcnt(5)
    s_mov_b32 s52, 0x1e6000
    buffer_load_dwordx4 a[116:119], v1, s[32:35], s52 offen offset:0 nt
    v_mfma_f32_16x16x32_bf16 v[24:27], a[88:91], v[12:15], v[24:27]
    v_add_f32_dpp v82, v35, v82 row_ror:12 row_mask:0xf bank_mask:0x4
    s_waitcnt vmcnt(5)
    s_mov_b32 s52, 0x1e7000
    buffer_load_dwordx4 a[124:127], v1, s[32:35], s52 offen offset:0 nt
    v_mfma_f32_16x16x32_bf16 v[24:27], a[96:99], v[16:19], v[24:27]
    v_mov_b32_dpp v82, v36 row_ror:12 row_mask:0xf bank_mask:0x8
    s_waitcnt vmcnt(5)
    s_mov_b32 s52, 0x1f0000
    buffer_load_dwordx4 a[128:131], v1, s[32:35], s52 offen offset:0 nt
    v_mfma_f32_16x16x32_bf16 v[24:27], a[100:103], v[20:23], v[24:27]
    v_add_f32_dpp v82, v37, v82 row_ror:8 row_mask:0xf bank_mask:0x8
    s_waitcnt vmcnt(5)
    s_mov_b32 s52, 0x1f1000
    buffer_load_dwordx4 a[136:139], v1, s[32:35], s52 offen offset:0 nt
    v_mfma_f32_16x16x32_bf16 v[28:31], a[108:111], v[8:11], 0
    v_add_f32_dpp v82, v38, v82 row_ror:4 row_mask:0xf bank_mask:0x8
    s_waitcnt vmcnt(4)
    s_mov_b32 s52, 0x1f2000
    buffer_load_dwordx4 a[140:143], v1, s[32:35], s52 offen offset:0 nt
    v_mfma_f32_16x16x32_bf16 v[28:31], a[112:115], v[12:15], v[28:31]
    v_add_f32_dpp v82, v39, v82 quad_perm:[0,1,2,3] row_mask:0xf bank_mask:0x8
    v_cvt_pk_bf16_f32 v54, v82, v82
    v_and_b32 v54, 0xffff0000, v54
    v_mul_f32 v54, 0x3db504f3, v54
    v_cvt_pk_bf16_f32 v54, v54, v54
    v_and_b32 v54, 0xffff0000, v54
    v_max_f32 v80, v80, v54
    s_waitcnt vmcnt(4)
    s_mov_b32 s52, 0x1f3000
    buffer_load_dwordx4 a[144:147], v1, s[32:35], s52 offen offset:0 nt
    v_mfma_f32_16x16x32_bf16 v[28:31], a[116:119], v[16:19], v[28:31]
    v_mov_b32_dpp v83, v24 quad_perm:[0,1,2,3] row_mask:0xf bank_mask:0x1
    s_waitcnt vmcnt(4)
    s_mov_b32 s52, 0x1f4000
    buffer_load_dwordx4 a[152:155], v1, s[32:35], s52 offen offset:0 nt
    s_mov_b32 s54, 0xe000
    buffer_load_dwordx4 v[184:187], v4, s[44:47], s54 offen
    v_mfma_f32_16x16x32_bf16 v[28:31], a[124:127], v[20:23], v[28:31]
    v_add_f32_dpp v83, v25, v83 row_ror:12 row_mask:0xf bank_mask:0x1
    s_waitcnt vmcnt(5)
    s_mov_b32 s52, 0x1f5000
    buffer_load_dwordx4 a[156:159], v1, s[32:35], s52 offen offset:0 nt
    v_mfma_f32_16x16x32_bf16 v[32:35], a[128:131], v[8:11], 0
    v_add_f32_dpp v83, v26, v83 row_ror:8 row_mask:0xf bank_mask:0x1
    s_waitcnt vmcnt(5)
    s_mov_b32 s52, 0x1f6000
    buffer_load_dwordx4 a[164:167], v1, s[32:35], s52 offen offset:0 nt
    v_mfma_f32_16x16x32_bf16 v[32:35], a[136:139], v[12:15], v[32:35]
    v_add_f32_dpp v83, v27, v83 row_ror:4 row_mask:0xf bank_mask:0x1
    s_waitcnt vmcnt(5)
    s_mov_b32 s52, 0x1f7000
    buffer_load_dwordx4 a[168:171], v1, s[32:35], s52 offen offset:0 nt
    v_mfma_f32_16x16x32_bf16 v[32:35], a[140:143], v[16:19], v[32:35]
    v_mov_b32_dpp v83, v28 row_ror:4 row_mask:0xf bank_mask:0x2
    s_waitcnt vmcnt(5)
    s_mov_b32 s52, 0x0
    buffer_load_dwordx4 a[172:175], v2, s[36:39], s52 offen offset:0 nt
    v_mfma_f32_16x16x32_bf16 v[32:35], a[144:147], v[20:23], v[32:35]
    v_add_f32_dpp v83, v29, v83 quad_perm:[0,1,2,3] row_mask:0xf bank_mask:0x2
    s_waitcnt vmcnt(5)
    s_mov_b32 s52, 0x1000
    buffer_load_dwordx4 a[180:183], v2, s[36:39], s52 offen offset:0 nt
    v_mfma_f32_16x16x32_bf16 v[36:39], a[152:155], v[8:11], 0
    v_add_f32_dpp v83, v30, v83 row_ror:12 row_mask:0xf bank_mask:0x2
    s_waitcnt vmcnt(4)
    s_mov_b32 s52, 0x2000
    buffer_load_dwordx4 a[184:187], v2, s[36:39], s52 offen offset:0 nt
    v_mfma_f32_16x16x32_bf16 v[36:39], a[156:159], v[12:15], v[36:39]
    v_add_f32_dpp v83, v31, v83 row_ror:8 row_mask:0xf bank_mask:0x2
    s_waitcnt vmcnt(4)
    s_mov_b32 s52, 0x3000
    buffer_load_dwordx4 a[192:195], v2, s[36:39], s52 offen offset:0 nt
    v_mfma_f32_16x16x32_bf16 v[36:39], a[164:167], v[16:19], v[36:39]
    v_mov_b32_dpp v83, v32 row_ror:8 row_mask:0xf bank_mask:0x4
    s_waitcnt vmcnt(4)
    s_mov_b32 s52, 0x4000
    buffer_load_dwordx4 a[196:199], v2, s[36:39], s52 offen offset:0 nt
    s_mov_b32 s54, 0xf000
    buffer_load_dwordx4 v[188:191], v4, s[44:47], s54 offen
    v_mfma_f32_16x16x32_bf16 v[36:39], a[168:171], v[20:23], v[36:39]
    v_add_f32_dpp v83, v33, v83 row_ror:4 row_mask:0xf bank_mask:0x4
    s_nop 1
    v_add_f32_dpp v83, v34, v83 quad_perm:[0,1,2,3] row_mask:0xf bank_mask:0x4
    s_nop 1
    v_add_f32_dpp v83, v35, v83 row_ror:12 row_mask:0xf bank_mask:0x4
    s_nop 1
    v_mov_b32_dpp v83, v36 row_ror:12 row_mask:0xf bank_mask:0x8
    s_nop 1
    v_add_f32_dpp v83, v37, v83 row_ror:8 row_mask:0xf bank_mask:0x8
    s_nop 1
    v_add_f32_dpp v83, v38, v83 row_ror:4 row_mask:0xf bank_mask:0x8
    s_nop 1
    v_add_f32_dpp v83, v39, v83 quad_perm:[0,1,2,3] row_mask:0xf bank_mask:0x8
    v_cvt_pk_bf16_f32 v55, v83, v83
    v_and_b32 v55, 0xffff0000, v55
    v_mul_f32 v55, 0x3db504f3, v55
    v_cvt_pk_bf16_f32 v55, v55, v55
    v_and_b32 v55, 0xffff0000, v55
    v_max_f32 v80, v80, v55
    v_mov_b32 v123, s3
    v_lshlrev_b32 v123, 2, v123
    v_mov_b32 v124, 0
    v_max_f32_dpp v80, v80, v80 quad_perm:[1,0,3,2] row_mask:0xf bank_mask:0xf
    s_nop 1
    v_max_f32_dpp v80, v80, v80 quad_perm:[2,3,0,1] row_mask:0xf bank_mask:0xf
    s_nop 1
    v_max_f32_dpp v80, v80, v80 row_half_mirror row_mask:0xf bank_mask:0xf
    s_nop 1
    v_max_f32_dpp v80, v80, v80 row_mirror row_mask:0xf bank_mask:0xf
    v_mov_b32 v7, v80
    s_nop 1
    v_permlane16_swap_b32 v80, v7
    v_max_f32 v80, v80, v7
    s_waitcnt vmcnt(5)
    s_mov_b32 s52, 0x5000
    buffer_load_dwordx4 a[200:203], v2, s[36:39], s52 offen offset:0 nt
    v_mov_b32 v7, v80
    s_nop 1
    v_permlane32_swap_b32 v80, v7
    v_max_f32 v80, v80, v7
    ds_write_b32 v123, v80 offset:4096
    s_waitcnt lgkmcnt(0)
    s_barrier
    ds_read_b128 v[24:27], v124 offset:4096
    s_waitcnt lgkmcnt(0)
    v_max3_f32 v80, v24, v25, v26
    v_max_f32 v80, v80, v27
    v_sub_f32 v82, v40, v80
    v_mul_f32 v82, 0x3fb8aa3b, v82
    v_exp_f32 v82, v82
    s_nop 0
    v_cvt_pk_bf16_f32 v40, v82, v82
    v_mov_b32 v81, v82
    s_nop 0
    v_and_b32_dpp v56, v40, v5 quad_perm:[0,0,0,0] row_mask:0xf bank_mask:0xf
    v_and_b32_dpp v57, v40, v6 quad_perm:[0,0,0,0] row_mask:0xf bank_mask:0xf
    v_and_b32_dpp v58, v40, v5 quad_perm:[1,1,1,1] row_mask:0xf bank_mask:0xf
    v_and_b32_dpp v59, v40, v6 quad_perm:[1,1,1,1] row_mask:0xf bank_mask:0xf
    v_and_b32_dpp v60, v40, v5 quad_perm:[2,2,2,2] row_mask:0xf bank_mask:0xf
    v_and_b32_dpp v61, v40, v6 quad_perm:[2,2,2,2] row_mask:0xf bank_mask:0xf
    v_and_b32_dpp v62, v40, v5 quad_perm:[3,3,3,3] row_mask:0xf bank_mask:0xf
    v_and_b32_dpp v63, v40, v6 quad_perm:[3,3,3,3] row_mask:0xf bank_mask:0xf
    v_sub_f32 v82, v41, v80
    v_mul_f32 v82, 0x3fb8aa3b, v82
    s_waitcnt vmcnt(5)
    s_mov_b32 s52, 0x6000
    buffer_load_dwordx4 a[208:211], v2, s[36:39], s52 offen offset:0 nt
    v_exp_f32 v82, v82
    s_nop 0
    v_cvt_pk_bf16_f32 v41, v82, v82
    v_add_f32 v81, v81, v82
    v_mfma_f32_4x4x4_16b_bf16 v[72:75], v[56:57], a[172:173], 0 cbsz:2 abid:0
    v_mfma_f32_4x4x4_16b_bf16 v[76:79], v[56:57], a[174:175], 0 cbsz:2 abid:0
    v_and_b32_dpp v64, v41, v5 quad_perm:[0,0,0,0] row_mask:0xf bank_mask:0xf
    v_sub_f32 v82, v42, v80
    v_mul_f32 v82, 0x3fb8aa3b, v82
    v_exp_f32 v82, v82
    s_nop 0
    v_cvt_pk_bf16_f32 v42, v82, v82
    v_add_f32 v81, v81, v82
    v_mfma_f32_4x4x4_16b_bf16 v[72:75], v[58:59], a[180:181], v[72:75] cbsz:2 abid:0
    v_mfma_f32_4x4x4_16b_bf16 v[76:79], v[58:59], a[182:183], v[76:79] cbsz:2 abid:0
    v_and_b32_dpp v65, v41, v6 quad_perm:[0,0,0,0] row_mask:0xf bank_mask:0xf
    v_sub_f32 v82, v43, v80
    v_mul_f32 v82, 0x3fb8aa3b, v82
    v_exp_f32 v82, v82
    s_nop 0
    v_cvt_pk_bf16_f32 v43, v82, v82
    v_add_f32 v81, v81, v82
    v_sub_f32 v82, v44, v80
    s_waitcnt vmcnt(5)
    s_mov_b32 s52, 0x7000
    buffer_load_dwordx4 a[212:215], v2, s[36:39], s52 offen offset:0 nt
    v_mfma_f32_4x4x4_16b_bf16 v[72:75], v[60:61], a[184:185], v[72:75] cbsz:2 abid:0
    v_mfma_f32_4x4x4_16b_bf16 v[76:79], v[60:61], a[186:187], v[76:79] cbsz:2 abid:0
    v_and_b32_dpp v66, v41, v5 quad_perm:[1,1,1,1] row_mask:0xf bank_mask:0xf
    v_mul_f32 v82, 0x3fb8aa3b, v82
    v_exp_f32 v82, v82
    s_nop 0
    v_cvt_pk_bf16_f32 v44, v82, v82
    v_add_f32 v81, v81, v82
    v_sub_f32 v82, v45, v80
    v_mul_f32 v82, 0x3fb8aa3b, v82
    s_waitcnt vmcnt(5)
    s_mov_b32 s52, 0x10000
    buffer_load_dwordx4 a[220:223], v2, s[36:39], s52 offen offset:0 nt
    v_mfma_f32_4x4x4_16b_bf16 v[72:75], v[62:63], a[192:193], v[72:75] cbsz:2 abid:0
    v_mfma_f32_4x4x4_16b_bf16 v[76:79], v[62:63], a[194:195], v[76:79] cbsz:2 abid:0
    v_and_b32_dpp v67, v41, v6 quad_perm:[1,1,1,1] row_mask:0xf bank_mask:0xf
    v_exp_f32 v82, v82
    s_nop 0
    v_cvt_pk_bf16_f32 v45, v82, v82
    v_add_f32 v81, v81, v82
    v_sub_f32 v82, v46, v80
    v_mul_f32 v82, 0x3fb8aa3b, v82
    v_exp_f32 v82, v82
    s_waitcnt vmcnt(5)
    s_mov_b32 s52, 0x11000
    buffer_load_dwordx4 a[224:227], v2, s[36:39], s52 offen offset:0 nt
    v_mfma_f32_4x4x4_16b_bf16 v[72:75], v[56:57], a[196:197], v[72:75] cbsz:2 abid:1
    v_mfma_f32_4x4x4_16b_bf16 v[76:79], v[56:57], a[198:199], v[76:79] cbsz:2 abid:1
    v_and_b32_dpp v68, v41, v5 quad_perm:[2,2,2,2] row_mask:0xf bank_mask:0xf
    v_cvt_pk_bf16_f32 v46, v82, v82
    v_add_f32 v81, v81, v82
    v_sub_f32 v82, v47, v80
    v_mul_f32 v82, 0x3fb8aa3b, v82
    v_exp_f32 v82, v82
    s_nop 0
    v_cvt_pk_bf16_f32 v47, v82, v82
    s_waitcnt vmcnt(4)
    s_mov_b32 s52, 0x12000
    buffer_load_dwordx4 a[228:231], v2, s[36:39], s52 offen offset:0 nt
    v_mfma_f32_4x4x4_16b_bf16 v[72:75], v[58:59], a[200:201], v[72:75] cbsz:2 abid:1
    v_mfma_f32_4x4x4_16b_bf16 v[76:79], v[58:59], a[202:203], v[76:79] cbsz:2 abid:1
    v_and_b32_dpp v69, v41, v6 quad_perm:[2,2,2,2] row_mask:0xf bank_mask:0xf
    v_add_f32 v81, v81, v82
    v_sub_f32 v82, v48, v80
    v_mul_f32 v82, 0x3fb8aa3b, v82
    v_exp_f32 v82, v82
    s_nop 0
    v_cvt_pk_bf16_f32 v48, v82, v82
    v_add_f32 v81, v81, v82
    s_waitcnt vmcnt(4)
    s_mov_b32 s52, 0x13000
    buffer_load_dwordx4 a[236:239], v2, s[36:39], s52 offen offset:0 nt
    v_mfma_f32_4x4x4_16b_bf16 v[72:75], v[60:61], a[208:209], v[72:75] cbsz:2 abid:1
    v_mfma_f32_4x4x4_16b_bf16 v[76:79], v[60:61], a[210:211], v[76:79] cbsz:2 abid:1
    v_and_b32_dpp v70, v41, v5 quad_perm:[3,3,3,3] row_mask:0xf bank_mask:0xf
    v_sub_f32 v82, v49, v80
    v_mul_f32 v82, 0x3fb8aa3b, v82
    v_exp_f32 v82, v82
    s_nop 0
    v_cvt_pk_bf16_f32 v49, v82, v82
    v_add_f32 v81, v81, v82
    v_sub_f32 v82, v50, v80
    s_waitcnt vmcnt(4)
    s_mov_b32 s52, 0x14000
    buffer_load_dwordx4 a[240:243], v2, s[36:39], s52 offen offset:0 nt
    s_mov_b32 s54, 0x10000
    buffer_load_dwordx4 v[192:195], v4, s[44:47], s54 offen
    v_mfma_f32_4x4x4_16b_bf16 v[72:75], v[62:63], a[212:213], v[72:75] cbsz:2 abid:1
    v_mfma_f32_4x4x4_16b_bf16 v[76:79], v[62:63], a[214:215], v[76:79] cbsz:2 abid:1
    v_and_b32_dpp v71, v41, v6 quad_perm:[3,3,3,3] row_mask:0xf bank_mask:0xf
    v_mul_f32 v82, 0x3fb8aa3b, v82
    v_exp_f32 v82, v82
    s_nop 0
    v_cvt_pk_bf16_f32 v50, v82, v82
    v_add_f32 v81, v81, v82
    v_sub_f32 v82, v51, v80
    v_mul_f32 v82, 0x3fb8aa3b, v82
    s_waitcnt vmcnt(5)
    s_mov_b32 s52, 0x15000
    buffer_load_dwordx4 a[248:251], v2, s[36:39], s52 offen offset:0 nt
    v_mfma_f32_4x4x4_16b_bf16 v[72:75], v[56:57], a[220:221], v[72:75] cbsz:2 abid:2
    v_mfma_f32_4x4x4_16b_bf16 v[76:79], v[56:57], a[222:223], v[76:79] cbsz:2 abid:2
    v_exp_f32 v82, v82
    s_nop 0
    v_cvt_pk_bf16_f32 v51, v82, v82
    v_add_f32 v81, v81, v82
    v_sub_f32 v82, v52, v80
    v_mul_f32 v82, 0x3fb8aa3b, v82
    v_exp_f32 v82, v82
    s_waitcnt vmcnt(5)
    s_mov_b32 s52, 0x16000
    buffer_load_dwordx4 a[252:255], v2, s[36:39], s52 offen offset:0 nt
    v_mfma_f32_4x4x4_16b_bf16 v[72:75], v[58:59], a[224:225], v[72:75] cbsz:2 abid:2
    v_mfma_f32_4x4x4_16b_bf16 v[76:79], v[58:59], a[226:227], v[76:79] cbsz:2 abid:2
    v_cvt_pk_bf16_f32 v52, v82, v82
    v_add_f32 v81, v81, v82
    v_sub_f32 v82, v53, v80
    v_mul_f32 v82, 0x3fb8aa3b, v82
    v_exp_f32 v82, v82
    s_nop 0
    v_cvt_pk_bf16_f32 v53, v82, v82
    s_waitcnt vmcnt(5)
    s_mov_b32 s52, 0x17000
    buffer_load_dwordx4 a[36:39], v2, s[36:39], s52 offen offset:0 nt
    v_mfma_f32_4x4x4_16b_bf16 v[72:75], v[60:61], a[228:229], v[72:75] cbsz:2 abid:2
    v_mfma_f32_4x4x4_16b_bf16 v[76:79], v[60:61], a[230:231], v[76:79] cbsz:2 abid:2
    v_add_f32 v81, v81, v82
    v_sub_f32 v82, v54, v80
    v_mul_f32 v82, 0x3fb8aa3b, v82
    v_exp_f32 v82, v82
    s_nop 0
    v_cvt_pk_bf16_f32 v54, v82, v82
    v_add_f32 v81, v81, v82
    s_waitcnt vmcnt(5)
    s_mov_b32 s52, 0x20000
    buffer_load_dwordx4 a[48:51], v2, s[36:39], s52 offen offset:0 nt
    v_mfma_f32_4x4x4_16b_bf16 v[72:75], v[62:63], a[236:237], v[72:75] cbsz:2 abid:2
    v_mfma_f32_4x4x4_16b_bf16 v[76:79], v[62:63], a[238:239], v[76:79] cbsz:2 abid:2
    v_sub_f32 v82, v55, v80
    v_mul_f32 v82, 0x3fb8aa3b, v82
    v_exp_f32 v82, v82
    s_nop 0
    v_cvt_pk_bf16_f32 v55, v82, v82
    v_add_f32 v81, v81, v82
    s_nop 1
    v_add_f32_dpp v81, v81, v81 quad_perm:[1,0,3,2] row_mask:0xf bank_mask:0xf
    s_waitcnt vmcnt(5)
    s_mov_b32 s52, 0x21000
    buffer_load_dwordx4 a[64:67], v2, s[36:39], s52 offen offset:0 nt
    v_mfma_f32_4x4x4_16b_bf16 v[72:75], v[56:57], a[240:241], v[72:75] cbsz:2 abid:3
    v_mfma_f32_4x4x4_16b_bf16 v[76:79], v[56:57], a[242:243], v[76:79] cbsz:2 abid:3
    v_add_f32_dpp v81, v81, v81 quad_perm:[2,3,0,1] row_mask:0xf bank_mask:0xf
    s_nop 1
    v_add_f32_dpp v81, v81, v81 row_half_mirror row_mask:0xf bank_mask:0xf
    s_nop 1
    v_add_f32_dpp v81, v81, v81 row_mirror row_mask:0xf bank_mask:0xf
    v_mov_b32 v82, v81
    s_nop 1
    v_permlane16_swap_b32 v81, v82
    v_add_f32 v81, v81, v82
    s_waitcnt vmcnt(4)
    s_mov_b32 s52, 0x22000
    buffer_load_dwordx4 a[92:95], v2, s[36:39], s52 offen offset:0 nt
    v_mfma_f32_4x4x4_16b_bf16 v[72:75], v[58:59], a[248:249], v[72:75] cbsz:2 abid:3
    v_mfma_f32_4x4x4_16b_bf16 v[76:79], v[58:59], a[250:251], v[76:79] cbsz:2 abid:3
    v_mov_b32 v82, v81
    s_nop 1
    v_permlane32_swap_b32 v81, v82
    v_add_f32 v81, v81, v82
    v_add_u32 v123, 4112, v123
    ds_write2_b32 v123, v81, v121 offset0:0 offset1:4
    s_cmp_ge_u32 s59, 32
    s_cbranch_scc1 L_cleared
    s_mov_b32 s57, 0x40000
    v_mov_b32 v124, 0
L_clearpoll:
    global_load_dword v125, v124, s[26:27] sc1
    s_sub_u32 s57, s57, 1
    s_waitcnt vmcnt(0)
    v_readfirstlane_b32 s59, v125
    s_cmp_eq_u32 s57, 0
    s_cbranch_scc1 L_cleared
    s_cmp_ge_u32 s59, 32
    s_cbranch_scc0 L_clearpoll
L_cleared:
    s_waitcnt vmcnt(4)
    s_mov_b32 s52, 0x23000
    buffer_load_dwordx4 a[104:107], v2, s[36:39], s52 offen offset:0 nt
    v_mfma_f32_4x4x4_16b_bf16 v[72:75], v[60:61], a[252:253], v[72:75] cbsz:2 abid:3
    v_mfma_f32_4x4x4_16b_bf16 v[76:79], v[60:61], a[254:255], v[76:79] cbsz:2 abid:3
    v_mov_b32 v124, 0
    s_waitcnt lgkmcnt(0)
    s_barrier
    ds_read_b128 v[24:27], v124 offset:4112
    ds_read_b128 v[28:31], v124 offset:4128
    s_waitcnt vmcnt(4)
    s_mov_b32 s52, 0x24000
    buffer_load_dwordx4 a[132:135], v2, s[36:39], s52 offen offset:0 nt
    s_mov_b32 s54, 0x11000
    buffer_load_dwordx4 v[196:199], v4, s[44:47], s54 offen
    v_mfma_f32_4x4x4_16b_bf16 v[72:75], v[62:63], a[36:37], v[72:75] cbsz:2 abid:3
    v_mfma_f32_4x4x4_16b_bf16 v[76:79], v[62:63], a[38:39], v[76:79] cbsz:2 abid:3
    s_lshl_b32 s55, s50, 6
    s_add_u32 s55, s55, 0x80000
    v_lshlrev_b32 v123, 4, v0
    v_add_u32 v123, s55, v123
    v_cmp_eq_u32 vcc, 0, v0
    s_waitcnt lgkmcnt(0)
    s_waitcnt vmcnt(5)
    s_mov_b32 s52, 0x25000
    buffer_load_dwordx4 a[148:151], v2, s[36:39], s52 offen offset:0 nt
    v_mfma_f32_4x4x4_16b_bf16 v[72:75], v[64:65], a[48:49], v[72:75] cbsz:2 abid:0
    v_mfma_f32_4x4x4_16b_bf16 v[76:79], v[64:65], a[50:51], v[76:79] cbsz:2 abid:0
    v_and_b32_dpp v56, v42, v5 quad_perm:[0,0,0,0] row_mask:0xf bank_mask:0xf
    v_add_f32 v24, v24, v25
    v_add_f32 v26, v26, v27
    v_add_f32 v81, v24, v26
    v_cndmask_b32 v26, v30, v80, vcc
    v_cndmask_b32 v27, v31, v81, vcc
    v_min_u32 v32, -2, v26
    s_waitcnt vmcnt(5)
    s_mov_b32 s52, 0x26000
    buffer_load_dwordx4 a[160:163], v2, s[36:39], s52 offen offset:0 nt
    v_mfma_f32_4x4x4_16b_bf16 v[72:75], v[66:67], a[64:65], v[72:75] cbsz:2 abid:0
    v_mfma_f32_4x4x4_16b_bf16 v[76:79], v[66:67], a[66:67], v[76:79] cbsz:2 abid:0
    v_and_b32_dpp v57, v42, v6 quad_perm:[0,0,0,0] row_mask:0xf bank_mask:0xf
    v_min_u32 v33, -2, v27
    v_min_u32 v34, -2, v28
    v_min_u32 v35, -2, v29
    s_cmp_eq_u32 s3, 0
    s_cbranch_scc0 L_skip38
    s_mov_b64 exec, 15
    global_store_dwordx4 v123, v[32:35], s[28:29] sc1
    s_mov_b64 exec, -1
L_skip38:
    s_waitcnt vmcnt(5)
    s_mov_b32 s52, 0x27000
    buffer_load_dwordx4 a[188:191], v2, s[36:39], s52 offen offset:0 nt
    v_mfma_f32_4x4x4_16b_bf16 v[72:75], v[68:69], a[92:93], v[72:75] cbsz:2 abid:0
    v_mfma_f32_4x4x4_16b_bf16 v[76:79], v[68:69], a[94:95], v[76:79] cbsz:2 abid:0
    v_and_b32_dpp v58, v42, v5 quad_perm:[1,1,1,1] row_mask:0xf bank_mask:0xf
    s_waitcnt vmcnt(5)
    s_mov_b32 s52, 0x30000
    buffer_load_dwordx4 a[204:207], v2, s[36:39], s52 offen offset:0 nt
    v_mfma_f32_4x4x4_16b_bf16 v[72:75], v[70:71], a[104:105], v[72:75] cbsz:2 abid:0
    v_mfma_f32_4x4x4_16b_bf16 v[76:79], v[70:71], a[106:107], v[76:79] cbsz:2 abid:0
    v_and_b32_dpp v59, v42, v6 quad_perm:[1,1,1,1] row_mask:0xf bank_mask:0xf
    s_waitcnt vmcnt(5)
    s_mov_b32 s52, 0x31000
    buffer_load_dwordx4 a[232:235], v2, s[36:39], s52 offen offset:0 nt
    v_mfma_f32_4x4x4_16b_bf16 v[72:75], v[64:65], a[132:133], v[72:75] cbsz:2 abid:1
    v_mfma_f32_4x4x4_16b_bf16 v[76:79], v[64:65], a[134:135], v[76:79] cbsz:2 abid:1
    v_and_b32_dpp v60, v42, v5 quad_perm:[2,2,2,2] row_mask:0xf bank_mask:0xf
    s_waitcnt vmcnt(4)
    s_mov_b32 s52, 0x32000
    buffer_load_dwordx4 a[244:247], v2, s[36:39], s52 offen offset:0 nt
    v_mfma_f32_4x4x4_16b_bf16 v[72:75], v[66:67], a[148:149], v[72:75] cbsz:2 abid:1
    v_mfma_f32_4x4x4_16b_bf16 v[76:79], v[66:67], a[150:151], v[76:79] cbsz:2 abid:1
    v_and_b32_dpp v61, v42, v6 quad_perm:[2,2,2,2] row_mask:0xf bank_mask:0xf
    s_waitcnt vmcnt(4)
    s_mov_b32 s52, 0x33000
    buffer_load_dwordx4 a[20:23], v2, s[36:39], s52 offen offset:0 nt
    v_mfma_f32_4x4x4_16b_bf16 v[72:75], v[68:69], a[160:161], v[72:75] cbsz:2 abid:1
    v_mfma_f32_4x4x4_16b_bf16 v[76:79], v[68:69], a[162:163], v[76:79] cbsz:2 abid:1
    v_and_b32_dpp v62, v42, v5 quad_perm:[3,3,3,3] row_mask:0xf bank_mask:0xf
    s_waitcnt vmcnt(4)
    s_mov_b32 s52, 0x34000
    buffer_load_dwordx4 a[76:79], v2, s[36:39], s52 offen offset:0 nt
    s_mov_b32 s54, 0x12000
    buffer_load_dwordx4 v[200:203], v4, s[44:47], s54 offen
    v_mfma_f32_4x4x4_16b_bf16 v[72:75], v[70:71], a[188:189], v[72:75] cbsz:2 abid:1
    v_mfma_f32_4x4x4_16b_bf16 v[76:79], v[70:71], a[190:191], v[76:79] cbsz:2 abid:1
    v_and_b32_dpp v63, v42, v6 quad_perm:[3,3,3,3] row_mask:0xf bank_mask:0xf
    s_waitcnt vmcnt(5)
    s_mov_b32 s52, 0x35000
    buffer_load_dwordx4 a[120:123], v2, s[36:39], s52 offen offset:0 nt
    v_mfma_f32_4x4x4_16b_bf16 v[72:75], v[64:65], a[204:205], v[72:75] cbsz:2 abid:2
    v_mfma_f32_4x4x4_16b_bf16 v[76:79], v[64:65], a[206:207], v[76:79] cbsz:2 abid:2
    s_waitcnt vmcnt(5)
    s_mov_b32 s52, 0x36000
    buffer_load_dwordx4 a[176:179], v2, s[36:39], s52 offen offset:0 nt
    v_mfma_f32_4x4x4_16b_bf16 v[72:75], v[66:67], a[232:233], v[72:75] cbsz:2 abid:2
    v_mfma_f32_4x4x4_16b_bf16 v[76:79], v[66:67], a[234:235], v[76:79] cbsz:2 abid:2
    s_waitcnt vmcnt(5)
    s_mov_b32 s52, 0x37000
    buffer_load_dwordx4 a[216:219], v2, s[36:39], s52 offen offset:0 nt
    v_mfma_f32_4x4x4_16b_bf16 v[72:75], v[68:69], a[244:245], v[72:75] cbsz:2 abid:2
    v_mfma_f32_4x4x4_16b_bf16 v[76:79], v[68:69], a[246:247], v[76:79] cbsz:2 abid:2
    s_waitcnt vmcnt(5)
    s_mov_b32 s52, 0x40000
    buffer_load_dwordx4 a[0:3], v2, s[36:39], s52 offen offset:0 nt
    v_mfma_f32_4x4x4_16b_bf16 v[72:75], v[70:71], a[20:21], v[72:75] cbsz:2 abid:2
    v_mfma_f32_4x4x4_16b_bf16 v[76:79], v[70:71], a[22:23], v[76:79] cbsz:2 abid:2
    s_waitcnt vmcnt(5)
    s_mov_b32 s52, 0x41000
    buffer_load_dwordx4 a[4:7], v2, s[36:39], s52 offen offset:0 nt
    v_mfma_f32_4x4x4_16b_bf16 v[72:75], v[64:65], a[76:77], v[72:75] cbsz:2 abid:3
    v_mfma_f32_4x4x4_16b_bf16 v[76:79], v[64:65], a[78:79], v[76:79] cbsz:2 abid:3
    s_waitcnt vmcnt(4)
    s_mov_b32 s52, 0x42000
    buffer_load_dwordx4 a[8:11], v2, s[36:39], s52 offen offset:0 nt
    v_mfma_f32_4x4x4_16b_bf16 v[72:75], v[66:67], a[120:121], v[72:75] cbsz:2 abid:3
    v_mfma_f32_4x4x4_16b_bf16 v[76:79], v[66:67], a[122:123], v[76:79] cbsz:2 abid:3
    s_waitcnt vmcnt(4)
    s_mov_b32 s52, 0x43000
    buffer_load_dwordx4 a[12:15], v2, s[36:39], s52 offen offset:0 nt
    v_mfma_f32_4x4x4_16b_bf16 v[72:75], v[68:69], a[176:177], v[72:75] cbsz:2 abid:3
    v_mfma_f32_4x4x4_16b_bf16 v[76:79], v[68:69], a[178:179], v[76:79] cbsz:2 abid:3
    s_waitcnt vmcnt(4)
    s_mov_b32 s52, 0x44000
    buffer_load_dwordx4 a[16:19], v2, s[36:39], s52 offen offset:0 nt
    s_mov_b32 s54, 0x13000
    buffer_load_dwordx4 v[204:207], v4, s[44:47], s54 offen
    v_mfma_f32_4x4x4_16b_bf16 v[72:75], v[70:71], a[216:217], v[72:75] cbsz:2 abid:3
    v_mfma_f32_4x4x4_16b_bf16 v[76:79], v[70:71], a[218:219], v[76:79] cbsz:2 abid:3
    s_waitcnt vmcnt(5)
    s_mov_b32 s52, 0x45000
    buffer_load_dwordx4 a[24:27], v2, s[36:39], s52 offen offset:0 nt
    v_mfma_f32_4x4x4_16b_bf16 v[72:75], v[56:57], a[0:1], v[72:75] cbsz:2 abid:0
    v_mfma_f32_4x4x4_16b_bf16 v[76:79], v[56:57], a[2:3], v[76:79] cbsz:2 abid:0
    v_and_b32_dpp v64, v43, v5 quad_perm:[0,0,0,0] row_mask:0xf bank_mask:0xf
    s_waitcnt vmcnt(5)
    s_mov_b32 s52, 0x46000
    buffer_load_dwordx4 a[28:31], v2, s[36:39], s52 offen offset:0 nt
    v_mfma_f32_4x4x4_16b_bf16 v[72:75], v[58:59], a[4:5], v[72:75] cbsz:2 abid:0
    v_mfma_f32_4x4x4_16b_bf16 v[76:79], v[58:59], a[6:7], v[76:79] cbsz:2 abid:0
    v_and_b32_dpp v65, v43, v6 quad_perm:[0,0,0,0] row_mask:0xf bank_mask:0xf
    s_waitcnt vmcnt(5)
    s_mov_b32 s52, 0x47000
    buffer_load_dwordx4 a[32:35], v2, s[36:39], s52 offen offset:0 nt
    v_mfma_f32_4x4x4_16b_bf16 v[72:75], v[60:61], a[8:9], v[72:75] cbsz:2 abid:0
    v_mfma_f32_4x4x4_16b_bf16 v[76:79], v[60:61], a[10:11], v[76:79] cbsz:2 abid:0
    v_and_b32_dpp v66, v43, v5 quad_perm:[1,1,1,1] row_mask:0xf bank_mask:0xf
    s_cmp_eq_u32 s3, 0
    s_cbranch_scc0 L_skip39
    s_mov_b32 s31, 1
    s_atomic_add s31, s[60:61], 0 glc
L_skip39:
    s_waitcnt vmcnt(5)
    s_mov_b32 s52, 0x50000
    buffer_load_dwordx4 a[40:43], v2, s[36:39], s52 offen offset:0 nt
    v_mfma_f32_4x4x4_16b_bf16 v[72:75], v[62:63], a[12:13], v[72:75] cbsz:2 abid:0
    v_mfma_f32_4x4x4_16b_bf16 v[76:79], v[62:63], a[14:15], v[76:79] cbsz:2 abid:0
    v_and_b32_dpp v67, v43, v6 quad_perm:[1,1,1,1] row_mask:0xf bank_mask:0xf
    s_waitcnt vmcnt(5)
    s_mov_b32 s52, 0x51000
    buffer_load_dwordx4 a[44:47], v2, s[36:39], s52 offen offset:0 nt
    v_mfma_f32_4x4x4_16b_bf16 v[72:75], v[56:57], a[16:17], v[72:75] cbsz:2 abid:1
    v_mfma_f32_4x4x4_16b_bf16 v[76:79], v[56:57], a[18:19], v[76:79] cbsz:2 abid:1
    v_and_b32_dpp v68, v43, v5 quad_perm:[2,2,2,2] row_mask:0xf bank_mask:0xf
    s_waitcnt vmcnt(4)
    s_mov_b32 s52, 0x52000
    buffer_load_dwordx4 a[52:55], v2, s[36:39], s52 offen offset:0 nt
    v_mfma_f32_4x4x4_16b_bf16 v[72:75], v[58:59], a[24:25], v[72:75] cbsz:2 abid:1
    v_mfma_f32_4x4x4_16b_bf16 v[76:79], v[58:59], a[26:27], v[76:79] cbsz:2 abid:1
    v_and_b32_dpp v69, v43, v6 quad_perm:[2,2,2,2] row_mask:0xf bank_mask:0xf
    s_waitcnt vmcnt(4)
    s_mov_b32 s52, 0x53000
    buffer_load_dwordx4 a[56:59], v2, s[36:39], s52 offen offset:0 nt
    v_mfma_f32_4x4x4_16b_bf16 v[72:75], v[60:61], a[28:29], v[72:75] cbsz:2 abid:1
    v_mfma_f32_4x4x4_16b_bf16 v[76:79], v[60:61], a[30:31], v[76:79] cbsz:2 abid:1
    v_and_b32_dpp v70, v43, v5 quad_perm:[3,3,3,3] row_mask:0xf bank_mask:0xf
    s_waitcnt vmcnt(4)
    s_mov_b32 s52, 0x54000
    buffer_load_dwordx4 a[60:63], v2, s[36:39], s52 offen offset:0 nt
    s_mov_b32 s54, 0x14000
    buffer_load_dwordx4 v[208:211], v4, s[44:47], s54 offen
    v_mfma_f32_4x4x4_16b_bf16 v[72:75], v[62:63], a[32:33], v[72:75] cbsz:2 abid:1
    v_mfma_f32_4x4x4_16b_bf16 v[76:79], v[62:63], a[34:35], v[76:79] cbsz:2 abid:1
    v_and_b32_dpp v71, v43, v6 quad_perm:[3,3,3,3] row_mask:0xf bank_mask:0xf
    s_waitcnt vmcnt(5)
    s_mov_b32 s52, 0x55000
    buffer_load_dwordx4 a[68:71], v2, s[36:39], s52 offen offset:0 nt
    v_mfma_f32_4x4x4_16b_bf16 v[72:75], v[56:57], a[40:41], v[72:75] cbsz:2 abid:2
    v_mfma_f32_4x4x4_16b_bf16 v[76:79], v[56:57], a[42:43], v[76:79] cbsz:2 abid:2
    s_waitcnt vmcnt(5)
    s_mov_b32 s52, 0x56000
    buffer_load_dwordx4 a[72:75], v2, s[36:39], s52 offen offset:0 nt
    v_mfma_f32_4x4x4_16b_bf16 v[72:75], v[58:59], a[44:45], v[72:75] cbsz:2 abid:2
    v_mfma_f32_4x4x4_16b_bf16 v[76:79], v[58:59], a[46:47], v[76:79] cbsz:2 abid:2
    s_waitcnt vmcnt(5)
    s_mov_b32 s52, 0x57000
    buffer_load_dwordx4 a[80:83], v2, s[36:39], s52 offen offset:0 nt
    v_mfma_f32_4x4x4_16b_bf16 v[72:75], v[60:61], a[52:53], v[72:75] cbsz:2 abid:2
    v_mfma_f32_4x4x4_16b_bf16 v[76:79], v[60:61], a[54:55], v[76:79] cbsz:2 abid:2
    s_waitcnt vmcnt(5)
    s_mov_b32 s52, 0x60000
    buffer_load_dwordx4 a[84:87], v2, s[36:39], s52 offen offset:0 nt
    v_mfma_f32_4x4x4_16b_bf16 v[72:75], v[62:63], a[56:57], v[72:75] cbsz:2 abid:2
    v_mfma_f32_4x4x4_16b_bf16 v[76:79], v[62:63], a[58:59], v[76:79] cbsz:2 abid:2
    s_waitcnt vmcnt(5)
    s_mov_b32 s52, 0x61000
    buffer_load_dwordx4 a[88:91], v2, s[36:39], s52 offen offset:0 nt
    v_mfma_f32_4x4x4_16b_bf16 v[72:75], v[56:57], a[60:61], v[72:75] cbsz:2 abid:3
    v_mfma_f32_4x4x4_16b_bf16 v[76:79], v[56:57], a[62:63], v[76:79] cbsz:2 abid:3
    s_cmp_eq_u32 s3, 0
    s_cbranch_scc0 L_skip40
    s_waitcnt lgkmcnt(0)
    v_mov_b32 v119, s31
    ds_write_b32 v111, v119
L_skip40:
    s_waitcnt lgkmcnt(0)
    s_barrier
    ds_read_b32 v119, v111
    s_waitcnt vmcnt(4)
    s_mov_b32 s52, 0x62000
    buffer_load_dwordx4 a[96:99], v2, s[36:39], s52 offen offset:0 nt
    v_mfma_f32_4x4x4_16b_bf16 v[72:75], v[58:59], a[68:69], v[72:75] cbsz:2 abid:3
    v_mfma_f32_4x4x4_16b_bf16 v[76:79], v[58:59], a[70:71], v[76:79] cbsz:2 abid:3
    s_waitcnt lgkmcnt(0)
    v_readfirstlane_b32 s62, v119
    s_nop 1
    s_cmp_ge_i32 s62, 23
    s_cselect_b32 s63, 2, 0
    s_cmp_eq_u32 s63, 0
    s_cbranch_scc0 L_skip41
    s_waitcnt vmcnt(4)
L_skip41:
    s_mov_b32 s52, 0x63000
    buffer_load_dwordx4 a[100:103], v2, s[36:39], s52 offen offset:0 nt
    s_cmp_eq_u32 s63, 0
    s_cbranch_scc0 L_skip42
    s_waitcnt vmcnt(4)
L_skip42:
    s_mov_b32 s52, 0x64000
    buffer_load_dwordx4 a[108:111], v2, s[36:39], s52 offen offset:0 nt
    s_mov_b32 s54, 0x15000
    buffer_load_dwordx4 v[212:215], v4, s[44:47], s54 offen
    s_waitcnt vmcnt(7)
    s_cmp_eq_u32 s63, 0
    s_cbranch_scc0 L_skip43
    s_waitcnt vmcnt(5)
L_skip43:
    s_mov_b32 s52, 0x65000
    buffer_load_dwordx4 a[112:115], v2, s[36:39], s52 offen offset:0 nt
    v_mfma_f32_4x4x4_16b_bf16 v[72:75], v[60:61], a[72:73], v[72:75] cbsz:2 abid:3
    v_mfma_f32_4x4x4_16b_bf16 v[76:79], v[60:61], a[74:75], v[76:79] cbsz:2 abid:3
    s_waitcnt vmcnt(7)
    s_cmp_eq_u32 s63, 0
    s_cbranch_scc0 L_skip44
    s_waitcnt vmcnt(5)
L_skip44:
    s_mov_b32 s52, 0x66000
    buffer_load_dwordx4 a[116:119], v2, s[36:39], s52 offen offset:0 nt
    v_mfma_f32_4x4x4_16b_bf16 v[72:75], v[62:63], a[80:81], v[72:75] cbsz:2 abid:3
    v_mfma_f32_4x4x4_16b_bf16 v[76:79], v[62:63], a[82:83], v[76:79] cbsz:2 abid:3
    s_waitcnt vmcnt(7)
    s_cmp_eq_u32 s63, 0
    s_cbranch_scc0 L_skip45
    s_waitcnt vmcnt(5)
L_skip45:
    s_mov_b32 s52, 0x67000
    buffer_load_dwordx4 a[124:127], v2, s[36:39], s52 offen offset:0 nt
    v_mfma_f32_4x4x4_16b_bf16 v[72:75], v[64:65], a[84:85], v[72:75] cbsz:2 abid:0
    v_mfma_f32_4x4x4_16b_bf16 v[76:79], v[64:65], a[86:87], v[76:79] cbsz:2 abid:0
    v_and_b32_dpp v56, v44, v5 quad_perm:[0,0,0,0] row_mask:0xf bank_mask:0xf
    s_cmp_eq_u32 s3, 0
    s_cbranch_scc0 L_skip46
    s_mov_b32 s31, 1
    s_atomic_add s31, s[60:61], 2048 glc
L_skip46:
    s_waitcnt vmcnt(7)
    s_cmp_eq_u32 s63, 0
    s_cbranch_scc0 L_skip47
    s_waitcnt vmcnt(5)
L_skip47:
    s_mov_b32 s52, 0x70000
    buffer_load_dwordx4 a[128:131], v2, s[36:39], s52 offen offset:0 nt
    v_mfma_f32_4x4x4_16b_bf16 v[72:75], v[66:67], a[88:89], v[72:75] cbsz:2 abid:0
    v_mfma_f32_4x4x4_16b_bf16 v[76:79], v[66:67], a[90:91], v[76:79] cbsz:2 abid:0
    v_and_b32_dpp v57, v44, v6 quad_perm:[0,0,0,0] row_mask:0xf bank_mask:0xf
    s_waitcnt vmcnt(7)
    s_cmp_eq_u32 s63, 0
    s_cbranch_scc0 L_skip48
    s_waitcnt vmcnt(5)
L_skip48:
    s_mov_b32 s52, 0x71000
    buffer_load_dwordx4 a[136:139], v2, s[36:39], s52 offen offset:0 nt
    v_mfma_f32_4x4x4_16b_bf16 v[72:75], v[68:69], a[96:97], v[72:75] cbsz:2 abid:0
    v_mfma_f32_4x4x4_16b_bf16 v[76:79], v[68:69], a[98:99], v[76:79] cbsz:2 abid:0
    v_and_b32_dpp v58, v44, v5 quad_perm:[1,1,1,1] row_mask:0xf bank_mask:0xf
    s_waitcnt vmcnt(7)
    s_cmp_eq_u32 s63, 0
    s_cbranch_scc0 L_skip49
    s_waitcnt vmcnt(4)
L_skip49:
    s_mov_b32 s52, 0x72000
    buffer_load_dwordx4 a[140:143], v2, s[36:39], s52 offen offset:0 nt
    v_mfma_f32_4x4x4_16b_bf16 v[72:75], v[70:71], a[100:101], v[72:75] cbsz:2 abid:0
    v_mfma_f32_4x4x4_16b_bf16 v[76:79], v[70:71], a[102:103], v[76:79] cbsz:2 abid:0
    v_and_b32_dpp v59, v44, v6 quad_perm:[1,1,1,1] row_mask:0xf bank_mask:0xf
    s_waitcnt vmcnt(7)
    s_cmp_eq_u32 s63, 0
    s_cbranch_scc0 L_skip50
    s_waitcnt vmcnt(4)
L_skip50:
    s_mov_b32 s52, 0x73000
    buffer_load_dwordx4 a[144:147], v2, s[36:39], s52 offen offset:0 nt
    v_mfma_f32_4x4x4_16b_bf16 v[72:75], v[64:65], a[108:109], v[72:75] cbsz:2 abid:1
    v_mfma_f32_4x4x4_16b_bf16 v[76:79], v[64:65], a[110:111], v[76:79] cbsz:2 abid:1
    v_and_b32_dpp v60, v44, v5 quad_perm:[2,2,2,2] row_mask:0xf bank_mask:0xf
    s_waitcnt vmcnt(6)
    s_cmp_eq_u32 s63, 0
    s_cbranch_scc0 L_skip51
    s_waitcnt vmcnt(4)
L_skip51:
    s_mov_b32 s52, 0x74000
    buffer_load_dwordx4 a[152:155], v2, s[36:39], s52 offen offset:0 nt
    s_mov_b32 s54, 0x16000
    buffer_load_dwordx4 v[216:219], v4, s[44:47], s54 offen
    v_mfma_f32_4x4x4_16b_bf16 v[72:75], v[66:67], a[112:113], v[72:75] cbsz:2 abid:1
    v_mfma_f32_4x4x4_16b_bf16 v[76:79], v[66:67], a[114:115], v[76:79] cbsz:2 abid:1
    v_and_b32_dpp v61, v44, v6 quad_perm:[2,2,2,2] row_mask:0xf bank_mask:0xf
    s_waitcnt vmcnt(7)
    s_cmp_eq_u32 s63, 0
    s_cbranch_scc0 L_skip52
    s_waitcnt vmcnt(5)
L_skip52:
    s_mov_b32 s52, 0x75000
    buffer_load_dwordx4 a[156:159], v2, s[36:39], s52 offen offset:0 nt
    v_mfma_f32_4x4x4_16b_bf16 v[72:75], v[68:69], a[116:117], v[72:75] cbsz:2 abid:1
    v_mfma_f32_4x4x4_16b_bf16 v[76:79], v[68:69], a[118:119], v[76:79] cbsz:2 abid:1
    v_and_b32_dpp v62, v44, v5 quad_perm:[3,3,3,3] row_mask:0xf bank_mask:0xf
    s_waitcnt vmcnt(7)
    s_cmp_eq_u32 s63, 0
    s_cbranch_scc0 L_skip53
    s_waitcnt vmcnt(5)
L_skip53:
    s_mov_b32 s52, 0x76000
    buffer_load_dwordx4 a[164:167], v2, s[36:39], s52 offen offset:0 nt
    v_mfma_f32_4x4x4_16b_bf16 v[72:75], v[70:71], a[124:125], v[72:75] cbsz:2 abid:1
    v_mfma_f32_4x4x4_16b_bf16 v[76:79], v[70:71], a[126:127], v[76:79] cbsz:2 abid:1
    v_and_b32_dpp v63, v44, v6 quad_perm:[3,3,3,3] row_mask:0xf bank_mask:0xf
    s_waitcnt vmcnt(7)
    s_cmp_eq_u32 s63, 0
    s_cbranch_scc0 L_skip54
    s_waitcnt vmcnt(5)
L_skip54:
    s_mov_b32 s52, 0x77000
    buffer_load_dwordx4 a[168:171], v2, s[36:39], s52 offen offset:0 nt
    v_mfma_f32_4x4x4_16b_bf16 v[72:75], v[64:65], a[128:129], v[72:75] cbsz:2 abid:2
    v_mfma_f32_4x4x4_16b_bf16 v[76:79], v[64:65], a[130:131], v[76:79] cbsz:2 abid:2
    s_waitcnt vmcnt(7)
    s_cmp_eq_u32 s63, 0
    s_cbranch_scc0 L_skip55
    s_waitcnt vmcnt(5)
L_skip55:
    s_mov_b32 s52, 0x80000
    buffer_load_dwordx4 a[172:175], v2, s[36:39], s52 offen offset:0 nt
    v_mfma_f32_4x4x4_16b_bf16 v[72:75], v[66:67], a[136:137], v[72:75] cbsz:2 abid:2
    v_mfma_f32_4x4x4_16b_bf16 v[76:79], v[66:67], a[138:139], v[76:79] cbsz:2 abid:2
    s_waitcnt vmcnt(7)
    s_cmp_eq_u32 s63, 0
    s_cbranch_scc0 L_skip56
    s_waitcnt vmcnt(5)
L_skip56:
    s_mov_b32 s52, 0x81000
    buffer_load_dwordx4 a[180:183], v2, s[36:39], s52 offen offset:0 nt
    v_mfma_f32_4x4x4_16b_bf16 v[72:75], v[68:69], a[140:141], v[72:75] cbsz:2 abid:2
    v_mfma_f32_4x4x4_16b_bf16 v[76:79], v[68:69], a[142:143], v[76:79] cbsz:2 abid:2
    s_cmp_eq_u32 s3, 0
    s_cbranch_scc0 L_skip57
    s_waitcnt lgkmcnt(0)
    v_mov_b32 v119, s31
    ds_write_b32 v111, v119
L_skip57:
    s_waitcnt lgkmcnt(0)
    s_barrier
    ds_read_b32 v119, v111
    s_waitcnt vmcnt(7)
    s_cmp_eq_u32 s63, 0
    s_cbranch_scc0 L_skip58
    s_waitcnt vmcnt(4)
L_skip58:
    s_mov_b32 s52, 0x82000
    buffer_load_dwordx4 a[184:187], v2, s[36:39], s52 offen offset:0 nt
    v_mfma_f32_4x4x4_16b_bf16 v[72:75], v[70:71], a[144:145], v[72:75] cbsz:2 abid:2
    v_mfma_f32_4x4x4_16b_bf16 v[76:79], v[70:71], a[146:147], v[76:79] cbsz:2 abid:2
    s_waitcnt lgkmcnt(0)
    v_readfirstlane_b32 s62, v119
    s_nop 1
    s_cmp_ge_i32 s62, 23
    s_cselect_b32 s63, 2, 0
    s_waitcnt vmcnt(7)
    s_cmp_eq_u32 s63, 0
    s_cbranch_scc0 L_skip59
    s_waitcnt vmcnt(4)
L_skip59:
    s_mov_b32 s52, 0x83000
    buffer_load_dwordx4 a[192:195], v2, s[36:39], s52 offen offset:0 nt
    v_mfma_f32_4x4x4_16b_bf16 v[72:75], v[64:65], a[152:153], v[72:75] cbsz:2 abid:3
    v_mfma_f32_4x4x4_16b_bf16 v[76:79], v[64:65], a[154:155], v[76:79] cbsz:2 abid:3
    s_waitcnt vmcnt(6)
    s_cmp_eq_u32 s63, 0
    s_cbranch_scc0 L_skip60
    s_waitcnt vmcnt(4)
L_skip60:
    s_mov_b32 s52, 0x84000
    buffer_load_dwordx4 a[196:199], v2, s[36:39], s52 offen offset:0 nt
    s_mov_b32 s54, 0x17000
    buffer_load_dwordx4 v[220:223], v4, s[44:47], s54 offen
    v_mfma_f32_4x4x4_16b_bf16 v[72:75], v[66:67], a[156:157], v[72:75] cbsz:2 abid:3
    v_mfma_f32_4x4x4_16b_bf16 v[76:79], v[66:67], a[158:159], v[76:79] cbsz:2 abid:3
    s_waitcnt vmcnt(7)
    s_cmp_eq_u32 s63, 0
    s_cbranch_scc0 L_skip61
    s_waitcnt vmcnt(5)
L_skip61:
    s_mov_b32 s52, 0x85000
    buffer_load_dwordx4 a[200:203], v2, s[36:39], s52 offen offset:0 nt
    v_mfma_f32_4x4x4_16b_bf16 v[72:75], v[68:69], a[164:165], v[72:75] cbsz:2 abid:3
    v_mfma_f32_4x4x4_16b_bf16 v[76:79], v[68:69], a[166:167], v[76:79] cbsz:2 abid:3
    s_waitcnt vmcnt(7)
    s_cmp_eq_u32 s63, 0
    s_cbranch_scc0 L_skip62
    s_waitcnt vmcnt(5)
L_skip62:
    s_mov_b32 s52, 0x86000
    buffer_load_dwordx4 a[208:211], v2, s[36:39], s52 offen offset:0 nt
    v_mfma_f32_4x4x4_16b_bf16 v[72:75], v[70:71], a[168:169], v[72:75] cbsz:2 abid:3
    v_mfma_f32_4x4x4_16b_bf16 v[76:79], v[70:71], a[170:171], v[76:79] cbsz:2 abid:3
    s_waitcnt vmcnt(7)
    s_cmp_eq_u32 s63, 0
    s_cbranch_scc0 L_skip63
    s_waitcnt vmcnt(5)
L_skip63:
    s_mov_b32 s52, 0x87000
    buffer_load_dwordx4 a[212:215], v2, s[36:39], s52 offen offset:0 nt
    v_mfma_f32_4x4x4_16b_bf16 v[72:75], v[56:57], a[172:173], v[72:75] cbsz:2 abid:0
    v_mfma_f32_4x4x4_16b_bf16 v[76:79], v[56:57], a[174:175], v[76:79] cbsz:2 abid:0
    v_and_b32_dpp v64, v45, v5 quad_perm:[0,0,0,0] row_mask:0xf bank_mask:0xf
    s_cmp_eq_u32 s3, 0
    s_cbranch_scc0 L_skip64
    s_mov_b32 s31, 1
    s_atomic_add s31, s[60:61], 4096 glc
L_skip64:
    s_waitcnt vmcnt(7)
    s_cmp_eq_u32 s63, 0
    s_cbranch_scc0 L_skip65
    s_waitcnt vmcnt(5)
L_skip65:
    s_mov_b32 s52, 0x90000
    buffer_load_dwordx4 a[220:223], v2, s[36:39], s52 offen offset:0 nt
    v_mfma_f32_4x4x4_16b_bf16 v[72:75], v[58:59], a[180:181], v[72:75] cbsz:2 abid:0
    v_mfma_f32_4x4x4_16b_bf16 v[76:79], v[58:59], a[182:183], v[76:79] cbsz:2 abid:0
    v_and_b32_dpp v65, v45, v6 quad_perm:[0,0,0,0] row_mask:0xf bank_mask:0xf
    s_waitcnt vmcnt(7)
    s_cmp_eq_u32 s63, 0
    s_cbranch_scc0 L_skip66
    s_waitcnt vmcnt(5)
L_skip66:
    s_mov_b32 s52, 0x91000
    buffer_load_dwordx4 a[224:227], v2, s[36:39], s52 offen offset:0 nt
    v_mfma_f32_4x4x4_16b_bf16 v[72:75], v[60:61], a[184:185], v[72:75] cbsz:2 abid:0
    v_mfma_f32_4x4x4_16b_bf16 v[76:79], v[60:61], a[186:187], v[76:79] cbsz:2 abid:0
    v_and_b32_dpp v66, v45, v5 quad_perm:[1,1,1,1] row_mask:0xf bank_mask:0xf
    s_waitcnt vmcnt(7)
    s_cmp_eq_u32 s63, 0
    s_cbranch_scc0 L_skip67
    s_waitcnt vmcnt(4)
L_skip67:
    s_mov_b32 s52, 0x92000
    buffer_load_dwordx4 a[228:231], v2, s[36:39], s52 offen offset:0 nt
    v_mfma_f32_4x4x4_16b_bf16 v[72:75], v[62:63], a[192:193], v[72:75] cbsz:2 abid:0
    v_mfma_f32_4x4x4_16b_bf16 v[76:79], v[62:63], a[194:195], v[76:79] cbsz:2 abid:0
    v_and_b32_dpp v67, v45, v6 quad_perm:[1,1,1,1] row_mask:0xf bank_mask:0xf
    s_waitcnt vmcnt(7)
    s_cmp_eq_u32 s63, 0
    s_cbranch_scc0 L_skip68
    s_waitcnt vmcnt(4)
L_skip68:
    s_mov_b32 s52, 0x93000
    buffer_load_dwordx4 a[236:239], v2, s[36:39], s52 offen offset:0 nt
    v_mfma_f32_4x4x4_16b_bf16 v[72:75], v[56:57], a[196:197], v[72:75] cbsz:2 abid:1
    v_mfma_f32_4x4x4_16b_bf16 v[76:79], v[56:57], a[198:199], v[76:79] cbsz:2 abid:1
    v_and_b32_dpp v68, v45, v5 quad_perm:[2,2,2,2] row_mask:0xf bank_mask:0xf
    s_waitcnt vmcnt(6)
    s_cmp_eq_u32 s63, 0
    s_cbranch_scc0 L_skip69
    s_waitcnt vmcnt(4)
L_skip69:
    s_mov_b32 s52, 0x94000
    buffer_load_dwordx4 a[240:243], v2, s[36:39], s52 offen offset:0 nt
    s_mov_b32 s54, 0x18000
    buffer_load_dwordx4 v[224:227], v4, s[44:47], s54 offen
    v_mfma_f32_4x4x4_16b_bf16 v[72:75], v[58:59], a[200:201], v[72:75] cbsz:2 abid:1
    v_mfma_f32_4x4x4_16b_bf16 v[76:79], v[58:59], a[202:203], v[76:79] cbsz:2 abid:1
    v_and_b32_dpp v69, v45, v6 quad_perm:[2,2,2,2] row_mask:0xf bank_mask:0xf
    s_waitcnt vmcnt(7)
    s_cmp_eq_u32 s63, 0
    s_cbranch_scc0 L_skip70
    s_waitcnt vmcnt(5)
L_skip70:
    s_mov_b32 s52, 0x95000
    buffer_load_dwordx4 a[248:251], v2, s[36:39], s52 offen offset:0 nt
    v_mfma_f32_4x4x4_16b_bf16 v[72:75], v[60:61], a[208:209], v[72:75] cbsz:2 abid:1
    v_mfma_f32_4x4x4_16b_bf16 v[76:79], v[60:61], a[210:211], v[76:79] cbsz:2 abid:1
    v_and_b32_dpp v70, v45, v5 quad_perm:[3,3,3,3] row_mask:0xf bank_mask:0xf
    s_waitcnt vmcnt(7)
    s_cmp_eq_u32 s63, 0
    s_cbranch_scc0 L_skip71
    s_waitcnt vmcnt(5)
L_skip71:
    s_mov_b32 s52, 0x96000
    buffer_load_dwordx4 a[252:255], v2, s[36:39], s52 offen offset:0 nt
    v_mfma_f32_4x4x4_16b_bf16 v[72:75], v[62:63], a[212:213], v[72:75] cbsz:2 abid:1
    v_mfma_f32_4x4x4_16b_bf16 v[76:79], v[62:63], a[214:215], v[76:79] cbsz:2 abid:1
    v_and_b32_dpp v71, v45, v6 quad_perm:[3,3,3,3] row_mask:0xf bank_mask:0xf
    s_waitcnt vmcnt(7)
    s_cmp_eq_u32 s63, 0
    s_cbranch_scc0 L_skip72
    s_waitcnt vmcnt(5)
L_skip72:
    s_mov_b32 s52, 0x97000
    buffer_load_dwordx4 a[36:39], v2, s[36:39], s52 offen offset:0 nt
    v_mfma_f32_4x4x4_16b_bf16 v[72:75], v[56:57], a[220:221], v[72:75] cbsz:2 abid:2
    v_mfma_f32_4x4x4_16b_bf16 v[76:79], v[56:57], a[222:223], v[76:79] cbsz:2 abid:2
    s_waitcnt vmcnt(7)
    s_cmp_eq_u32 s63, 0
    s_cbranch_scc0 L_skip73
    s_waitcnt vmcnt(5)
L_skip73:
    s_mov_b32 s52, 0xa0000
    buffer_load_dwordx4 a[48:51], v2, s[36:39], s52 offen offset:0 nt
    v_mfma_f32_4x4x4_16b_bf16 v[72:75], v[58:59], a[224:225], v[72:75] cbsz:2 abid:2
    v_mfma_f32_4x4x4_16b_bf16 v[76:79], v[58:59], a[226:227], v[76:79] cbsz:2 abid:2
    s_waitcnt vmcnt(7)
    s_cmp_eq_u32 s63, 0
    s_cbranch_scc0 L_skip74
    s_waitcnt vmcnt(5)
L_skip74:
    s_mov_b32 s52, 0xa1000
    buffer_load_dwordx4 a[64:67], v2, s[36:39], s52 offen offset:0 nt
    v_mfma_f32_4x4x4_16b_bf16 v[72:75], v[60:61], a[228:229], v[72:75] cbsz:2 abid:2
    v_mfma_f32_4x4x4_16b_bf16 v[76:79], v[60:61], a[230:231], v[76:79] cbsz:2 abid:2
    s_cmp_eq_u32 s3, 0
    s_cbranch_scc0 L_skip75
    s_waitcnt lgkmcnt(0)
    v_mov_b32 v119, s31
    ds_write_b32 v111, v119
L_skip75:
    s_waitcnt lgkmcnt(0)
    s_barrier
    ds_read_b32 v119, v111
    s_waitcnt vmcnt(7)
    s_cmp_eq_u32 s63, 0
    s_cbranch_scc0 L_skip76
    s_waitcnt vmcnt(4)
L_skip76:
    s_mov_b32 s52, 0xa2000
    buffer_load_dwordx4 a[92:95], v2, s[36:39], s52 offen offset:0 nt
    v_mfma_f32_4x4x4_16b_bf16 v[72:75], v[62:63], a[236:237], v[72:75] cbsz:2 abid:2
    v_mfma_f32_4x4x4_16b_bf16 v[76:79], v[62:63], a[238:239], v[76:79] cbsz:2 abid:2
    s_waitcnt lgkmcnt(0)
    v_readfirstlane_b32 s62, v119
    s_nop 1
    s_cmp_ge_i32 s62, 23
    s_cselect_b32 s63, 2, 0
    s_waitcnt vmcnt(7)
    s_cmp_eq_u32 s63, 0
    s_cbranch_scc0 L_skip77
    s_waitcnt vmcnt(4)
L_skip77:
    s_mov_b32 s52, 0xa3000
    buffer_load_dwordx4 a[104:107], v2, s[36:39], s52 offen offset:0 nt
    v_mfma_f32_4x4x4_16b_bf16 v[72:75], v[56:57], a[240:241], v[72:75] cbsz:2 abid:3
    v_mfma_f32_4x4x4_16b_bf16 v[76:79], v[56:57], a[242:243], v[76:79] cbsz:2 abid:3
    s_waitcnt vmcnt(6)
    s_cmp_eq_u32 s63, 0
    s_cbranch_scc0 L_skip78
    s_waitcnt vmcnt(4)
L_skip78:
    s_mov_b32 s52, 0xa4000
    buffer_load_dwordx4 a[132:135], v2, s[36:39], s52 offen offset:0 nt
    s_mov_b32 s54, 0x19000
    buffer_load_dwordx4 v[228:231], v4, s[44:47], s54 offen
    v_mfma_f32_4x4x4_16b_bf16 v[72:75], v[58:59], a[248:249], v[72:75] cbsz:2 abid:3
    v_mfma_f32_4x4x4_16b_bf16 v[76:79], v[58:59], a[250:251], v[76:79] cbsz:2 abid:3
    s_waitcnt vmcnt(7)
    s_cmp_eq_u32 s63, 0
    s_cbranch_scc0 L_skip79
    s_waitcnt vmcnt(5)
L_skip79:
    s_mov_b32 s52, 0xa5000
    buffer_load_dwordx4 a[148:151], v2, s[36:39], s52 offen offset:0 nt
    v_mfma_f32_4x4x4_16b_bf16 v[72:75], v[60:61], a[252:253], v[72:75] cbsz:2 abid:3
    v_mfma_f32_4x4x4_16b_bf16 v[76:79], v[60:61], a[254:255], v[76:79] cbsz:2 abid:3
    s_waitcnt vmcnt(7)
    s_cmp_eq_u32 s63, 0
    s_cbranch_scc0 L_skip80
    s_waitcnt vmcnt(5)
L_skip80:
    s_mov_b32 s52, 0xa6000
    buffer_load_dwordx4 a[160:163], v2, s[36:39], s52 offen offset:0 nt
    v_mfma_f32_4x4x4_16b_bf16 v[72:75], v[62:63], a[36:37], v[72:75] cbsz:2 abid:3
    v_mfma_f32_4x4x4_16b_bf16 v[76:79], v[62:63], a[38:39], v[76:79] cbsz:2 abid:3
    s_waitcnt vmcnt(7)
    s_cmp_eq_u32 s63, 0
    s_cbranch_scc0 L_skip81
    s_waitcnt vmcnt(5)
L_skip81:
    s_mov_b32 s52, 0xa7000
    buffer_load_dwordx4 a[188:191], v2, s[36:39], s52 offen offset:0 nt
    v_mfma_f32_4x4x4_16b_bf16 v[72:75], v[64:65], a[48:49], v[72:75] cbsz:2 abid:0
    v_mfma_f32_4x4x4_16b_bf16 v[76:79], v[64:65], a[50:51], v[76:79] cbsz:2 abid:0
    v_and_b32_dpp v56, v46, v5 quad_perm:[0,0,0,0] row_mask:0xf bank_mask:0xf
    s_cmp_eq_u32 s3, 0
    s_cbranch_scc0 L_skip82
    s_mov_b32 s31, 1
    s_atomic_add s31, s[60:61], 6144 glc
L_skip82:
    s_waitcnt vmcnt(7)
    s_cmp_eq_u32 s63, 0
    s_cbranch_scc0 L_skip83
    s_waitcnt vmcnt(5)
L_skip83:
    s_mov_b32 s52, 0xb0000
    buffer_load_dwordx4 a[204:207], v2, s[36:39], s52 offen offset:0 nt
    v_mfma_f32_4x4x4_16b_bf16 v[72:75], v[66:67], a[64:65], v[72:75] cbsz:2 abid:0
    v_mfma_f32_4x4x4_16b_bf16 v[76:79], v[66:67], a[66:67], v[76:79] cbsz:2 abid:0
    v_and_b32_dpp v57, v46, v6 quad_perm:[0,0,0,0] row_mask:0xf bank_mask:0xf
    s_waitcnt vmcnt(7)
    s_cmp_eq_u32 s63, 0
    s_cbranch_scc0 L_skip84
    s_waitcnt vmcnt(5)
L_skip84:
    s_mov_b32 s52, 0xb1000
    buffer_load_dwordx4 a[232:235], v2, s[36:39], s52 offen offset:0 nt
    v_mfma_f32_4x4x4_16b_bf16 v[72:75], v[68:69], a[92:93], v[72:75] cbsz:2 abid:0
    v_mfma_f32_4x4x4_16b_bf16 v[76:79], v[68:69], a[94:95], v[76:79] cbsz:2 abid:0
    v_and_b32_dpp v58, v46, v5 quad_perm:[1,1,1,1] row_mask:0xf bank_mask:0xf
    s_waitcnt vmcnt(7)
    s_cmp_eq_u32 s63, 0
    s_cbranch_scc0 L_skip85
    s_waitcnt vmcnt(4)
L_skip85:
    s_mov_b32 s52, 0xb2000
    buffer_load_dwordx4 a[244:247], v2, s[36:39], s52 offen offset:0 nt
    v_mfma_f32_4x4x4_16b_bf16 v[72:75], v[70:71], a[104:105], v[72:75] cbsz:2 abid:0
    v_mfma_f32_4x4x4_16b_bf16 v[76:79], v[70:71], a[106:107], v[76:79] cbsz:2 abid:0
    v_and_b32_dpp v59, v46, v6 quad_perm:[1,1,1,1] row_mask:0xf bank_mask:0xf
    s_waitcnt vmcnt(7)
    s_cmp_eq_u32 s63, 0
    s_cbranch_scc0 L_skip86
    s_waitcnt vmcnt(4)
L_skip86:
    s_mov_b32 s52, 0xb3000
    buffer_load_dwordx4 a[20:23], v2, s[36:39], s52 offen offset:0 nt
    v_mfma_f32_4x4x4_16b_bf16 v[72:75], v[64:65], a[132:133], v[72:75] cbsz:2 abid:1
    v_mfma_f32_4x4x4_16b_bf16 v[76:79], v[64:65], a[134:135], v[76:79] cbsz:2 abid:1
    v_and_b32_dpp v60, v46, v5 quad_perm:[2,2,2,2] row_mask:0xf bank_mask:0xf
    s_waitcnt vmcnt(6)
    s_cmp_eq_u32 s63, 0
    s_cbranch_scc0 L_skip87
    s_waitcnt vmcnt(4)
L_skip87:
    s_mov_b32 s52, 0xb4000
    buffer_load_dwordx4 a[76:79], v2, s[36:39], s52 offen offset:0 nt
    s_mov_b32 s54, 0x1a000
    buffer_load_dwordx4 v[232:235], v4, s[44:47], s54 offen
    v_mfma_f32_4x4x4_16b_bf16 v[72:75], v[66:67], a[148:149], v[72:75] cbsz:2 abid:1
    v_mfma_f32_4x4x4_16b_bf16 v[76:79], v[66:67], a[150:151], v[76:79] cbsz:2 abid:1
    v_and_b32_dpp v61, v46, v6 quad_perm:[2,2,2,2] row_mask:0xf bank_mask:0xf
    s_waitcnt vmcnt(7)
    s_cmp_eq_u32 s63, 0
    s_cbranch_scc0 L_skip88
    s_waitcnt vmcnt(5)
L_skip88:
    s_mov_b32 s52, 0xb5000
    buffer_load_dwordx4 a[120:123], v2, s[36:39], s52 offen offset:0 nt
    v_mfma_f32_4x4x4_16b_bf16 v[72:75], v[68:69], a[160:161], v[72:75] cbsz:2 abid:1
    v_mfma_f32_4x4x4_16b_bf16 v[76:79], v[68:69], a[162:163], v[76:79] cbsz:2 abid:1
    v_and_b32_dpp v62, v46, v5 quad_perm:[3,3,3,3] row_mask:0xf bank_mask:0xf
    s_waitcnt vmcnt(7)
    s_cmp_eq_u32 s63, 0
    s_cbranch_scc0 L_skip89
    s_waitcnt vmcnt(5)
L_skip89:
    s_mov_b32 s52, 0xb6000
    buffer_load_dwordx4 a[176:179], v2, s[36:39], s52 offen offset:0 nt
    v_mfma_f32_4x4x4_16b_bf16 v[72:75], v[70:71], a[188:189], v[72:75] cbsz:2 abid:1
    v_mfma_f32_4x4x4_16b_bf16 v[76:79], v[70:71], a[190:191], v[76:79] cbsz:2 abid:1
    v_and_b32_dpp v63, v46, v6 quad_perm:[3,3,3,3] row_mask:0xf bank_mask:0xf
    s_waitcnt vmcnt(7)
    s_cmp_eq_u32 s63, 0
    s_cbranch_scc0 L_skip90
    s_waitcnt vmcnt(5)
L_skip90:
    s_mov_b32 s52, 0xb7000
    buffer_load_dwordx4 a[216:219], v2, s[36:39], s52 offen offset:0 nt
    v_mfma_f32_4x4x4_16b_bf16 v[72:75], v[64:65], a[204:205], v[72:75] cbsz:2 abid:2
    v_mfma_f32_4x4x4_16b_bf16 v[76:79], v[64:65], a[206:207], v[76:79] cbsz:2 abid:2
    s_waitcnt vmcnt(7)
    s_cmp_eq_u32 s63, 0
    s_cbranch_scc0 L_skip91
    s_waitcnt vmcnt(5)
L_skip91:
    s_mov_b32 s52, 0xc0000
    buffer_load_dwordx4 a[0:3], v2, s[36:39], s52 offen offset:0 nt
    v_mfma_f32_4x4x4_16b_bf16 v[72:75], v[66:67], a[232:233], v[72:75] cbsz:2 abid:2
    v_mfma_f32_4x4x4_16b_bf16 v[76:79], v[66:67], a[234:235], v[76:79] cbsz:2 abid:2
    s_waitcnt vmcnt(7)
    s_cmp_eq_u32 s63, 0
    s_cbranch_scc0 L_skip92
    s_waitcnt vmcnt(5)
L_skip92:
    s_mov_b32 s52, 0xc1000
    buffer_load_dwordx4 a[4:7], v2, s[36:39], s52 offen offset:0 nt
    v_mfma_f32_4x4x4_16b_bf16 v[72:75], v[68:69], a[244:245], v[72:75] cbsz:2 abid:2
    v_mfma_f32_4x4x4_16b_bf16 v[76:79], v[68:69], a[246:247], v[76:79] cbsz:2 abid:2
    s_cmp_eq_u32 s3, 0
    s_cbranch_scc0 L_skip93
    s_waitcnt lgkmcnt(0)
    v_mov_b32 v119, s31
    ds_write_b32 v111, v119
L_skip93:
    s_waitcnt lgkmcnt(0)
    s_barrier
    ds_read_b32 v119, v111
    s_waitcnt vmcnt(7)
    s_cmp_eq_u32 s63, 0
    s_cbranch_scc0 L_skip94
    s_waitcnt vmcnt(4)
L_skip94:
    s_mov_b32 s52, 0xc2000
    buffer_load_dwordx4 a[8:11], v2, s[36:39], s52 offen offset:0 nt
    v_mfma_f32_4x4x4_16b_bf16 v[72:75], v[70:71], a[20:21], v[72:75] cbsz:2 abid:2
    v_mfma_f32_4x4x4_16b_bf16 v[76:79], v[70:71], a[22:23], v[76:79] cbsz:2 abid:2
    s_waitcnt lgkmcnt(0)
    v_readfirstlane_b32 s62, v119
    s_nop 1
    s_cmp_ge_i32 s62, 23
    s_cselect_b32 s63, 2, 0
    s_waitcnt vmcnt(7)
    s_cmp_eq_u32 s63, 0
    s_cbranch_scc0 L_skip95
    s_waitcnt vmcnt(4)
L_skip95:
    s_mov_b32 s52, 0xc3000
    buffer_load_dwordx4 a[12:15], v2, s[36:39], s52 offen offset:0 nt
    v_mfma_f32_4x4x4_16b_bf16 v[72:75], v[64:65], a[76:77], v[72:75] cbsz:2 abid:3
    v_mfma_f32_4x4x4_16b_bf16 v[76:79], v[64:65], a[78:79], v[76:79] cbsz:2 abid:3
    s_waitcnt vmcnt(6)
    s_cmp_eq_u32 s63, 0
    s_cbranch_scc0 L_skip96
    s_waitcnt vmcnt(4)
L_skip96:
    s_mov_b32 s52, 0xc4000
    buffer_load_dwordx4 a[16:19], v2, s[36:39], s52 offen offset:0 nt
    s_mov_b32 s54, 0x1b000
    buffer_load_dwordx4 v[236:239], v4, s[44:47], s54 offen
    v_mfma_f32_4x4x4_16b_bf16 v[72:75], v[66:67], a[120:121], v[72:75] cbsz:2 abid:3
    v_mfma_f32_4x4x4_16b_bf16 v[76:79], v[66:67], a[122:123], v[76:79] cbsz:2 abid:3
    s_waitcnt vmcnt(7)
    s_cmp_eq_u32 s63, 0
    s_cbranch_scc0 L_skip97
    s_waitcnt vmcnt(5)
L_skip97:
    s_mov_b32 s52, 0xc5000
    buffer_load_dwordx4 a[24:27], v2, s[36:39], s52 offen offset:0 nt
    v_mfma_f32_4x4x4_16b_bf16 v[72:75], v[68:69], a[176:177], v[72:75] cbsz:2 abid:3
    v_mfma_f32_4x4x4_16b_bf16 v[76:79], v[68:69], a[178:179], v[76:79] cbsz:2 abid:3
    s_waitcnt vmcnt(7)
    s_cmp_eq_u32 s63, 0
    s_cbranch_scc0 L_skip98
    s_waitcnt vmcnt(5)
L_skip98:
    s_mov_b32 s52, 0xc6000
    buffer_load_dwordx4 a[28:31], v2, s[36:39], s52 offen offset:0 nt
    v_mfma_f32_4x4x4_16b_bf16 v[72:75], v[70:71], a[216:217], v[72:75] cbsz:2 abid:3
    v_mfma_f32_4x4x4_16b_bf16 v[76:79], v[70:71], a[218:219], v[76:79] cbsz:2 abid:3
    s_waitcnt vmcnt(7)
    s_cmp_eq_u32 s63, 0
    s_cbranch_scc0 L_skip99
    s_waitcnt vmcnt(5)
L_skip99:
    s_mov_b32 s52, 0xc7000
    buffer_load_dwordx4 a[32:35], v2, s[36:39], s52 offen offset:0 nt
    v_mfma_f32_4x4x4_16b_bf16 v[72:75], v[56:57], a[0:1], v[72:75] cbsz:2 abid:0
    v_mfma_f32_4x4x4_16b_bf16 v[76:79], v[56:57], a[2:3], v[76:79] cbsz:2 abid:0
    v_and_b32_dpp v64, v47, v5 quad_perm:[0,0,0,0] row_mask:0xf bank_mask:0xf
    s_cmp_eq_u32 s3, 0
    s_cbranch_scc0 L_skip100
    s_mov_b32 s31, 1
    s_atomic_add s31, s[60:61], 8192 glc
L_skip100:
    s_waitcnt vmcnt(7)
    s_cmp_eq_u32 s63, 0
    s_cbranch_scc0 L_skip101
    s_waitcnt vmcnt(5)
L_skip101:
    s_mov_b32 s52, 0xd0000
    buffer_load_dwordx4 a[40:43], v2, s[36:39], s52 offen offset:0 nt
    v_mfma_f32_4x4x4_16b_bf16 v[72:75], v[58:59], a[4:5], v[72:75] cbsz:2 abid:0
    v_mfma_f32_4x4x4_16b_bf16 v[76:79], v[58:59], a[6:7], v[76:79] cbsz:2 abid:0
    v_and_b32_dpp v65, v47, v6 quad_perm:[0,0,0,0] row_mask:0xf bank_mask:0xf
    s_waitcnt vmcnt(7)
    s_cmp_eq_u32 s63, 0
    s_cbranch_scc0 L_skip102
    s_waitcnt vmcnt(5)
L_skip102:
    s_mov_b32 s52, 0xd1000
    buffer_load_dwordx4 a[44:47], v2, s[36:39], s52 offen offset:0 nt
    v_mfma_f32_4x4x4_16b_bf16 v[72:75], v[60:61], a[8:9], v[72:75] cbsz:2 abid:0
    v_mfma_f32_4x4x4_16b_bf16 v[76:79], v[60:61], a[10:11], v[76:79] cbsz:2 abid:0
    v_and_b32_dpp v66, v47, v5 quad_perm:[1,1,1,1] row_mask:0xf bank_mask:0xf
    s_waitcnt vmcnt(7)
    s_cmp_eq_u32 s63, 0
    s_cbranch_scc0 L_skip103
    s_waitcnt vmcnt(4)
L_skip103:
    s_mov_b32 s52, 0xd2000
    buffer_load_dwordx4 a[52:55], v2, s[36:39], s52 offen offset:0 nt
    v_mfma_f32_4x4x4_16b_bf16 v[72:75], v[62:63], a[12:13], v[72:75] cbsz:2 abid:0
    v_mfma_f32_4x4x4_16b_bf16 v[76:79], v[62:63], a[14:15], v[76:79] cbsz:2 abid:0
    v_and_b32_dpp v67, v47, v6 quad_perm:[1,1,1,1] row_mask:0xf bank_mask:0xf
    s_waitcnt vmcnt(7)
    s_cmp_eq_u32 s63, 0
    s_cbranch_scc0 L_skip104
    s_waitcnt vmcnt(4)
L_skip104:
    s_mov_b32 s52, 0xd3000
    buffer_load_dwordx4 a[56:59], v2, s[36:39], s52 offen offset:0 nt
    v_mfma_f32_4x4x4_16b_bf16 v[72:75], v[56:57], a[16:17], v[72:75] cbsz:2 abid:1
    v_mfma_f32_4x4x4_16b_bf16 v[76:79], v[56:57], a[18:19], v[76:79] cbsz:2 abid:1
    v_and_b32_dpp v68, v47, v5 quad_perm:[2,2,2,2] row_mask:0xf bank_mask:0xf
    s_waitcnt vmcnt(6)
    s_cmp_eq_u32 s63, 0
    s_cbranch_scc0 L_skip105
    s_waitcnt vmcnt(4)
L_skip105:
    s_mov_b32 s52, 0xd4000
    buffer_load_dwordx4 a[60:63], v2, s[36:39], s52 offen offset:0 nt
    s_mov_b32 s54, 0x1c000
    buffer_load_dwordx4 v[240:243], v4, s[44:47], s54 offen
    v_mfma_f32_4x4x4_16b_bf16 v[72:75], v[58:59], a[24:25], v[72:75] cbsz:2 abid:1
    v_mfma_f32_4x4x4_16b_bf16 v[76:79], v[58:59], a[26:27], v[76:79] cbsz:2 abid:1
    v_and_b32_dpp v69, v47, v6 quad_perm:[2,2,2,2] row_mask:0xf bank_mask:0xf
    s_waitcnt vmcnt(7)
    s_cmp_eq_u32 s63, 0
    s_cbranch_scc0 L_skip106
    s_waitcnt vmcnt(5)
L_skip106:
    s_mov_b32 s52, 0xd5000
    buffer_load_dwordx4 a[68:71], v2, s[36:39], s52 offen offset:0 nt
    v_mfma_f32_4x4x4_16b_bf16 v[72:75], v[60:61], a[28:29], v[72:75] cbsz:2 abid:1
    v_mfma_f32_4x4x4_16b_bf16 v[76:79], v[60:61], a[30:31], v[76:79] cbsz:2 abid:1
    v_and_b32_dpp v70, v47, v5 quad_perm:[3,3,3,3] row_mask:0xf bank_mask:0xf
    s_waitcnt vmcnt(7)
    s_cmp_eq_u32 s63, 0
    s_cbranch_scc0 L_skip107
    s_waitcnt vmcnt(5)
L_skip107:
    s_mov_b32 s52, 0xd6000
    buffer_load_dwordx4 a[72:75], v2, s[36:39], s52 offen offset:0 nt
    v_mfma_f32_4x4x4_16b_bf16 v[72:75], v[62:63], a[32:33], v[72:75] cbsz:2 abid:1
    v_mfma_f32_4x4x4_16b_bf16 v[76:79], v[62:63], a[34:35], v[76:79] cbsz:2 abid:1
    v_and_b32_dpp v71, v47, v6 quad_perm:[3,3,3,3] row_mask:0xf bank_mask:0xf
    s_waitcnt vmcnt(7)
    s_cmp_eq_u32 s63, 0
    s_cbranch_scc0 L_skip108
    s_waitcnt vmcnt(5)
L_skip108:
    s_mov_b32 s52, 0xd7000
    buffer_load_dwordx4 a[80:83], v2, s[36:39], s52 offen offset:0 nt
    v_mfma_f32_4x4x4_16b_bf16 v[72:75], v[56:57], a[40:41], v[72:75] cbsz:2 abid:2
    v_mfma_f32_4x4x4_16b_bf16 v[76:79], v[56:57], a[42:43], v[76:79] cbsz:2 abid:2
    s_waitcnt vmcnt(7)
    s_cmp_eq_u32 s63, 0
    s_cbranch_scc0 L_skip109
    s_waitcnt vmcnt(5)
L_skip109:
    s_mov_b32 s52, 0xe0000
    buffer_load_dwordx4 a[84:87], v2, s[36:39], s52 offen offset:0 nt
    v_mfma_f32_4x4x4_16b_bf16 v[72:75], v[58:59], a[44:45], v[72:75] cbsz:2 abid:2
    v_mfma_f32_4x4x4_16b_bf16 v[76:79], v[58:59], a[46:47], v[76:79] cbsz:2 abid:2
    s_waitcnt vmcnt(7)
    s_cmp_eq_u32 s63, 0
    s_cbranch_scc0 L_skip110
    s_waitcnt vmcnt(5)
L_skip110:
    s_mov_b32 s52, 0xe1000
    buffer_load_dwordx4 a[88:91], v2, s[36:39], s52 offen offset:0 nt
    v_mfma_f32_4x4x4_16b_bf16 v[72:75], v[60:61], a[52:53], v[72:75] cbsz:2 abid:2
    v_mfma_f32_4x4x4_16b_bf16 v[76:79], v[60:61], a[54:55], v[76:79] cbsz:2 abid:2
    s_cmp_eq_u32 s3, 0
    s_cbranch_scc0 L_skip111
    s_waitcnt lgkmcnt(0)
    v_mov_b32 v119, s31
    ds_write_b32 v111, v119
L_skip111:
    s_waitcnt lgkmcnt(0)
    s_barrier
    ds_read_b32 v119, v111
    s_waitcnt vmcnt(7)
    s_cmp_eq_u32 s63, 0
    s_cbranch_scc0 L_skip112
    s_waitcnt vmcnt(4)
L_skip112:
    s_mov_b32 s52, 0xe2000
    buffer_load_dwordx4 a[96:99], v2, s[36:39], s52 offen offset:0 nt
    v_mfma_f32_4x4x4_16b_bf16 v[72:75], v[62:63], a[56:57], v[72:75] cbsz:2 abid:2
    v_mfma_f32_4x4x4_16b_bf16 v[76:79], v[62:63], a[58:59], v[76:79] cbsz:2 abid:2
    s_waitcnt lgkmcnt(0)
    v_readfirstlane_b32 s62, v119
    s_nop 1
    s_cmp_ge_i32 s62, 23
    s_cselect_b32 s63, 2, 0
    s_waitcnt vmcnt(7)
    s_cmp_eq_u32 s63, 0
    s_cbranch_scc0 L_skip113
    s_waitcnt vmcnt(4)
L_skip113:
    s_mov_b32 s52, 0xe3000
    buffer_load_dwordx4 a[100:103], v2, s[36:39], s52 offen offset:0 nt
    v_mfma_f32_4x4x4_16b_bf16 v[72:75], v[56:57], a[60:61], v[72:75] cbsz:2 abid:3
    v_mfma_f32_4x4x4_16b_bf16 v[76:79], v[56:57], a[62:63], v[76:79] cbsz:2 abid:3
    s_waitcnt vmcnt(6)
    s_cmp_eq_u32 s63, 0
    s_cbranch_scc0 L_skip114
    s_waitcnt vmcnt(4)
L_skip114:
    s_mov_b32 s52, 0xe4000
    buffer_load_dwordx4 a[108:111], v2, s[36:39], s52 offen offset:0 nt
    s_mov_b32 s54, 0x1d000
    buffer_load_dwordx4 v[244:247], v4, s[44:47], s54 offen
    v_mfma_f32_4x4x4_16b_bf16 v[72:75], v[58:59], a[68:69], v[72:75] cbsz:2 abid:3
    v_mfma_f32_4x4x4_16b_bf16 v[76:79], v[58:59], a[70:71], v[76:79] cbsz:2 abid:3
    s_waitcnt vmcnt(7)
    s_cmp_eq_u32 s63, 0
    s_cbranch_scc0 L_skip115
    s_waitcnt vmcnt(5)
L_skip115:
    s_mov_b32 s52, 0xe5000
    buffer_load_dwordx4 a[112:115], v2, s[36:39], s52 offen offset:0 nt
    v_mfma_f32_4x4x4_16b_bf16 v[72:75], v[60:61], a[72:73], v[72:75] cbsz:2 abid:3
    v_mfma_f32_4x4x4_16b_bf16 v[76:79], v[60:61], a[74:75], v[76:79] cbsz:2 abid:3
    s_waitcnt vmcnt(7)
    s_cmp_eq_u32 s63, 0
    s_cbranch_scc0 L_skip116
    s_waitcnt vmcnt(5)
L_skip116:
    s_mov_b32 s52, 0xe6000
    buffer_load_dwordx4 a[116:119], v2, s[36:39], s52 offen offset:0 nt
    v_mfma_f32_4x4x4_16b_bf16 v[72:75], v[62:63], a[80:81], v[72:75] cbsz:2 abid:3
    v_mfma_f32_4x4x4_16b_bf16 v[76:79], v[62:63], a[82:83], v[76:79] cbsz:2 abid:3
    s_waitcnt vmcnt(7)
    s_cmp_eq_u32 s63, 0
    s_cbranch_scc0 L_skip117
    s_waitcnt vmcnt(5)
L_skip117:
    s_mov_b32 s52, 0xe7000
    buffer_load_dwordx4 a[124:127], v2, s[36:39], s52 offen offset:0 nt
    v_mfma_f32_4x4x4_16b_bf16 v[72:75], v[64:65], a[84:85], v[72:75] cbsz:2 abid:0
    v_mfma_f32_4x4x4_16b_bf16 v[76:79], v[64:65], a[86:87], v[76:79] cbsz:2 abid:0
    v_and_b32_dpp v56, v48, v5 quad_perm:[0,0,0,0] row_mask:0xf bank_mask:0xf
    s_cmp_eq_u32 s3, 0
    s_cbranch_scc0 L_skip118
    s_mov_b32 s31, 1
    s_atomic_add s31, s[60:61], 10240 glc
L_skip118:
    s_waitcnt vmcnt(7)
    s_cmp_eq_u32 s63, 0
    s_cbranch_scc0 L_skip119
    s_waitcnt vmcnt(5)
L_skip119:
    s_mov_b32 s52, 0xf0000
    buffer_load_dwordx4 a[128:131], v2, s[36:39], s52 offen offset:0 nt
    v_mfma_f32_4x4x4_16b_bf16 v[72:75], v[66:67], a[88:89], v[72:75] cbsz:2 abid:0
    v_mfma_f32_4x4x4_16b_bf16 v[76:79], v[66:67], a[90:91], v[76:79] cbsz:2 abid:0
    v_and_b32_dpp v57, v48, v6 quad_perm:[0,0,0,0] row_mask:0xf bank_mask:0xf
    s_waitcnt vmcnt(7)
    s_cmp_eq_u32 s63, 0
    s_cbranch_scc0 L_skip120
    s_waitcnt vmcnt(5)
L_skip120:
    s_mov_b32 s52, 0xf1000
    buffer_load_dwordx4 a[136:139], v2, s[36:39], s52 offen offset:0 nt
    v_mfma_f32_4x4x4_16b_bf16 v[72:75], v[68:69], a[96:97], v[72:75] cbsz:2 abid:0
    v_mfma_f32_4x4x4_16b_bf16 v[76:79], v[68:69], a[98:99], v[76:79] cbsz:2 abid:0
    v_and_b32_dpp v58, v48, v5 quad_perm:[1,1,1,1] row_mask:0xf bank_mask:0xf
    s_waitcnt vmcnt(7)
    s_cmp_eq_u32 s63, 0
    s_cbranch_scc0 L_skip121
    s_waitcnt vmcnt(4)
L_skip121:
    s_mov_b32 s52, 0xf2000
    buffer_load_dwordx4 a[140:143], v2, s[36:39], s52 offen offset:0 nt
    v_mfma_f32_4x4x4_16b_bf16 v[72:75], v[70:71], a[100:101], v[72:75] cbsz:2 abid:0
    v_mfma_f32_4x4x4_16b_bf16 v[76:79], v[70:71], a[102:103], v[76:79] cbsz:2 abid:0
    v_and_b32_dpp v59, v48, v6 quad_perm:[1,1,1,1] row_mask:0xf bank_mask:0xf
    s_waitcnt vmcnt(7)
    s_cmp_eq_u32 s63, 0
    s_cbranch_scc0 L_skip122
    s_waitcnt vmcnt(4)
L_skip122:
    s_mov_b32 s52, 0xf3000
    buffer_load_dwordx4 a[144:147], v2, s[36:39], s52 offen offset:0 nt
    v_mfma_f32_4x4x4_16b_bf16 v[72:75], v[64:65], a[108:109], v[72:75] cbsz:2 abid:1
    v_mfma_f32_4x4x4_16b_bf16 v[76:79], v[64:65], a[110:111], v[76:79] cbsz:2 abid:1
    v_and_b32_dpp v60, v48, v5 quad_perm:[2,2,2,2] row_mask:0xf bank_mask:0xf
    s_waitcnt vmcnt(6)
    s_cmp_eq_u32 s63, 0
    s_cbranch_scc0 L_skip123
    s_waitcnt vmcnt(4)
L_skip123:
    s_mov_b32 s52, 0xf4000
    buffer_load_dwordx4 a[152:155], v2, s[36:39], s52 offen offset:0 nt
    s_mov_b32 s54, 0x1e000
    buffer_load_dwordx4 v[248:251], v4, s[44:47], s54 offen
    v_mfma_f32_4x4x4_16b_bf16 v[72:75], v[66:67], a[112:113], v[72:75] cbsz:2 abid:1
    v_mfma_f32_4x4x4_16b_bf16 v[76:79], v[66:67], a[114:115], v[76:79] cbsz:2 abid:1
    v_and_b32_dpp v61, v48, v6 quad_perm:[2,2,2,2] row_mask:0xf bank_mask:0xf
    s_waitcnt vmcnt(7)
    s_cmp_eq_u32 s63, 0
    s_cbranch_scc0 L_skip124
    s_waitcnt vmcnt(5)
L_skip124:
    s_mov_b32 s52, 0xf5000
    buffer_load_dwordx4 a[156:159], v2, s[36:39], s52 offen offset:0 nt
    v_mfma_f32_4x4x4_16b_bf16 v[72:75], v[68:69], a[116:117], v[72:75] cbsz:2 abid:1
    v_mfma_f32_4x4x4_16b_bf16 v[76:79], v[68:69], a[118:119], v[76:79] cbsz:2 abid:1
    v_and_b32_dpp v62, v48, v5 quad_perm:[3,3,3,3] row_mask:0xf bank_mask:0xf
    s_waitcnt vmcnt(7)
    s_cmp_eq_u32 s63, 0
    s_cbranch_scc0 L_skip125
    s_waitcnt vmcnt(5)
L_skip125:
    s_mov_b32 s52, 0xf6000
    buffer_load_dwordx4 a[164:167], v2, s[36:39], s52 offen offset:0 nt
    v_mfma_f32_4x4x4_16b_bf16 v[72:75], v[70:71], a[124:125], v[72:75] cbsz:2 abid:1
    v_mfma_f32_4x4x4_16b_bf16 v[76:79], v[70:71], a[126:127], v[76:79] cbsz:2 abid:1
    v_and_b32_dpp v63, v48, v6 quad_perm:[3,3,3,3] row_mask:0xf bank_mask:0xf
    s_waitcnt vmcnt(7)
    s_cmp_eq_u32 s63, 0
    s_cbranch_scc0 L_skip126
    s_waitcnt vmcnt(5)
L_skip126:
    s_mov_b32 s52, 0xf7000
    buffer_load_dwordx4 a[168:171], v2, s[36:39], s52 offen offset:0 nt
    v_mfma_f32_4x4x4_16b_bf16 v[72:75], v[64:65], a[128:129], v[72:75] cbsz:2 abid:2
    v_mfma_f32_4x4x4_16b_bf16 v[76:79], v[64:65], a[130:131], v[76:79] cbsz:2 abid:2
    s_waitcnt vmcnt(7)
    s_cmp_eq_u32 s63, 0
    s_cbranch_scc0 L_skip127
    s_waitcnt vmcnt(5)
L_skip127:
    s_mov_b32 s52, 0x100000
    buffer_load_dwordx4 a[172:175], v2, s[36:39], s52 offen offset:0 nt
    v_mfma_f32_4x4x4_16b_bf16 v[72:75], v[66:67], a[136:137], v[72:75] cbsz:2 abid:2
    v_mfma_f32_4x4x4_16b_bf16 v[76:79], v[66:67], a[138:139], v[76:79] cbsz:2 abid:2
    s_waitcnt vmcnt(7)
    s_cmp_eq_u32 s63, 0
    s_cbranch_scc0 L_skip128
    s_waitcnt vmcnt(5)
L_skip128:
    s_mov_b32 s52, 0x101000
    buffer_load_dwordx4 a[180:183], v2, s[36:39], s52 offen offset:0 nt
    v_mfma_f32_4x4x4_16b_bf16 v[72:75], v[68:69], a[140:141], v[72:75] cbsz:2 abid:2
    v_mfma_f32_4x4x4_16b_bf16 v[76:79], v[68:69], a[142:143], v[76:79] cbsz:2 abid:2
    s_cmp_eq_u32 s3, 0
    s_cbranch_scc0 L_skip129
    s_waitcnt lgkmcnt(0)
    v_mov_b32 v119, s31
    ds_write_b32 v111, v119
L_skip129:
    s_waitcnt lgkmcnt(0)
    s_barrier
    ds_read_b32 v119, v111
    s_waitcnt vmcnt(7)
    s_cmp_eq_u32 s63, 0
    s_cbranch_scc0 L_skip130
    s_waitcnt vmcnt(4)
L_skip130:
    s_mov_b32 s52, 0x102000
    buffer_load_dwordx4 a[184:187], v2, s[36:39], s52 offen offset:0 nt
    v_mfma_f32_4x4x4_16b_bf16 v[72:75], v[70:71], a[144:145], v[72:75] cbsz:2 abid:2
    v_mfma_f32_4x4x4_16b_bf16 v[76:79], v[70:71], a[146:147], v[76:79] cbsz:2 abid:2
    s_waitcnt lgkmcnt(0)
    v_readfirstlane_b32 s62, v119
    s_nop 1
    s_cmp_ge_i32 s62, 23
    s_cselect_b32 s63, 2, 0
    s_waitcnt vmcnt(7)
    s_cmp_eq_u32 s63, 0
    s_cbranch_scc0 L_skip131
    s_waitcnt vmcnt(4)
L_skip131:
    s_mov_b32 s52, 0x103000
    buffer_load_dwordx4 a[192:195], v2, s[36:39], s52 offen offset:0 nt
    v_mfma_f32_4x4x4_16b_bf16 v[72:75], v[64:65], a[152:153], v[72:75] cbsz:2 abid:3
    v_mfma_f32_4x4x4_16b_bf16 v[76:79], v[64:65], a[154:155], v[76:79] cbsz:2 abid:3
    s_waitcnt vmcnt(6)
    s_cmp_eq_u32 s63, 0
    s_cbranch_scc0 L_skip132
    s_waitcnt vmcnt(4)
L_skip132:
    s_mov_b32 s52, 0x104000
    buffer_load_dwordx4 a[196:199], v2, s[36:39], s52 offen offset:0 nt
    s_mov_b32 s54, 0x1f000
    buffer_load_dwordx4 v[252:255], v4, s[44:47], s54 offen
    v_mfma_f32_4x4x4_16b_bf16 v[72:75], v[66:67], a[156:157], v[72:75] cbsz:2 abid:3
    v_mfma_f32_4x4x4_16b_bf16 v[76:79], v[66:67], a[158:159], v[76:79] cbsz:2 abid:3
    s_waitcnt vmcnt(7)
    s_cmp_eq_u32 s63, 0
    s_cbranch_scc0 L_skip133
    s_waitcnt vmcnt(5)
L_skip133:
    s_mov_b32 s52, 0x105000
    buffer_load_dwordx4 a[200:203], v2, s[36:39], s52 offen offset:0 nt
    v_mfma_f32_4x4x4_16b_bf16 v[72:75], v[68:69], a[164:165], v[72:75] cbsz:2 abid:3
    v_mfma_f32_4x4x4_16b_bf16 v[76:79], v[68:69], a[166:167], v[76:79] cbsz:2 abid:3
    s_waitcnt vmcnt(7)
    s_cmp_eq_u32 s63, 0
    s_cbranch_scc0 L_skip134
    s_waitcnt vmcnt(5)
L_skip134:
    s_mov_b32 s52, 0x106000
    buffer_load_dwordx4 a[208:211], v2, s[36:39], s52 offen offset:0 nt
    v_mfma_f32_4x4x4_16b_bf16 v[72:75], v[70:71], a[168:169], v[72:75] cbsz:2 abid:3
    v_mfma_f32_4x4x4_16b_bf16 v[76:79], v[70:71], a[170:171], v[76:79] cbsz:2 abid:3
    s_waitcnt vmcnt(7)
    s_cmp_eq_u32 s63, 0
    s_cbranch_scc0 L_skip135
    s_waitcnt vmcnt(5)
L_skip135:
    s_mov_b32 s52, 0x107000
    buffer_load_dwordx4 a[212:215], v2, s[36:39], s52 offen offset:0 nt
    v_mfma_f32_4x4x4_16b_bf16 v[72:75], v[56:57], a[172:173], v[72:75] cbsz:2 abid:0
    v_mfma_f32_4x4x4_16b_bf16 v[76:79], v[56:57], a[174:175], v[76:79] cbsz:2 abid:0
    v_and_b32_dpp v64, v49, v5 quad_perm:[0,0,0,0] row_mask:0xf bank_mask:0xf
    s_cmp_eq_u32 s3, 0
    s_cbranch_scc0 L_skip136
    s_mov_b32 s31, 1
    s_atomic_add s31, s[60:61], 12288 glc
L_skip136:
    s_waitcnt vmcnt(7)
    s_cmp_eq_u32 s63, 0
    s_cbranch_scc0 L_skip137
    s_waitcnt vmcnt(5)
L_skip137:
    s_mov_b32 s52, 0x110000
    buffer_load_dwordx4 a[220:223], v2, s[36:39], s52 offen offset:0 nt
    v_mfma_f32_4x4x4_16b_bf16 v[72:75], v[58:59], a[180:181], v[72:75] cbsz:2 abid:0
    v_mfma_f32_4x4x4_16b_bf16 v[76:79], v[58:59], a[182:183], v[76:79] cbsz:2 abid:0
    v_and_b32_dpp v65, v49, v6 quad_perm:[0,0,0,0] row_mask:0xf bank_mask:0xf
    s_waitcnt vmcnt(7)
    s_cmp_eq_u32 s63, 0
    s_cbranch_scc0 L_skip138
    s_waitcnt vmcnt(5)
L_skip138:
    s_mov_b32 s52, 0x111000
    buffer_load_dwordx4 a[224:227], v2, s[36:39], s52 offen offset:0 nt
    v_mfma_f32_4x4x4_16b_bf16 v[72:75], v[60:61], a[184:185], v[72:75] cbsz:2 abid:0
    v_mfma_f32_4x4x4_16b_bf16 v[76:79], v[60:61], a[186:187], v[76:79] cbsz:2 abid:0
    v_and_b32_dpp v66, v49, v5 quad_perm:[1,1,1,1] row_mask:0xf bank_mask:0xf
    s_waitcnt vmcnt(7)
    s_cmp_eq_u32 s63, 0
    s_cbranch_scc0 L_skip139
    s_waitcnt vmcnt(4)
L_skip139:
    s_mov_b32 s52, 0x112000
    buffer_load_dwordx4 a[228:231], v2, s[36:39], s52 offen offset:0 nt
    v_mfma_f32_4x4x4_16b_bf16 v[72:75], v[62:63], a[192:193], v[72:75] cbsz:2 abid:0
    v_mfma_f32_4x4x4_16b_bf16 v[76:79], v[62:63], a[194:195], v[76:79] cbsz:2 abid:0
    v_and_b32_dpp v67, v49, v6 quad_perm:[1,1,1,1] row_mask:0xf bank_mask:0xf
    s_waitcnt vmcnt(7)
    s_cmp_eq_u32 s63, 0
    s_cbranch_scc0 L_skip140
    s_waitcnt vmcnt(4)
L_skip140:
    s_mov_b32 s52, 0x113000
    buffer_load_dwordx4 a[236:239], v2, s[36:39], s52 offen offset:0 nt
    v_mfma_f32_4x4x4_16b_bf16 v[72:75], v[56:57], a[196:197], v[72:75] cbsz:2 abid:1
    v_mfma_f32_4x4x4_16b_bf16 v[76:79], v[56:57], a[198:199], v[76:79] cbsz:2 abid:1
    v_and_b32_dpp v68, v49, v5 quad_perm:[2,2,2,2] row_mask:0xf bank_mask:0xf
    s_waitcnt vmcnt(6)
    s_cmp_eq_u32 s63, 0
    s_cbranch_scc0 L_skip141
    s_waitcnt vmcnt(4)
L_skip141:
    s_mov_b32 s52, 0x114000
    buffer_load_dwordx4 a[240:243], v2, s[36:39], s52 offen offset:0 nt
    v_mfma_f32_4x4x4_16b_bf16 v[72:75], v[58:59], a[200:201], v[72:75] cbsz:2 abid:1
    v_mfma_f32_4x4x4_16b_bf16 v[76:79], v[58:59], a[202:203], v[76:79] cbsz:2 abid:1
    v_and_b32_dpp v69, v49, v6 quad_perm:[2,2,2,2] row_mask:0xf bank_mask:0xf
    s_waitcnt vmcnt(6)
    s_cmp_eq_u32 s63, 0
    s_cbranch_scc0 L_skip142
    s_waitcnt vmcnt(4)
L_skip142:
    s_mov_b32 s52, 0x115000
    buffer_load_dwordx4 a[248:251], v2, s[36:39], s52 offen offset:0 nt
    v_mfma_f32_4x4x4_16b_bf16 v[72:75], v[60:61], a[208:209], v[72:75] cbsz:2 abid:1
    v_mfma_f32_4x4x4_16b_bf16 v[76:79], v[60:61], a[210:211], v[76:79] cbsz:2 abid:1
    v_and_b32_dpp v70, v49, v5 quad_perm:[3,3,3,3] row_mask:0xf bank_mask:0xf
    s_waitcnt vmcnt(6)
    s_cmp_eq_u32 s63, 0
    s_cbranch_scc0 L_skip143
    s_waitcnt vmcnt(4)
L_skip143:
    s_mov_b32 s52, 0x116000
    buffer_load_dwordx4 a[252:255], v2, s[36:39], s52 offen offset:0 nt
    v_mfma_f32_4x4x4_16b_bf16 v[72:75], v[62:63], a[212:213], v[72:75] cbsz:2 abid:1
    v_mfma_f32_4x4x4_16b_bf16 v[76:79], v[62:63], a[214:215], v[76:79] cbsz:2 abid:1
    v_and_b32_dpp v71, v49, v6 quad_perm:[3,3,3,3] row_mask:0xf bank_mask:0xf
    s_waitcnt vmcnt(6)
    s_cmp_eq_u32 s63, 0
    s_cbranch_scc0 L_skip144
    s_waitcnt vmcnt(4)
L_skip144:
    s_mov_b32 s52, 0x117000
    buffer_load_dwordx4 a[36:39], v2, s[36:39], s52 offen offset:0 nt
    v_mfma_f32_4x4x4_16b_bf16 v[72:75], v[56:57], a[220:221], v[72:75] cbsz:2 abid:2
    v_mfma_f32_4x4x4_16b_bf16 v[76:79], v[56:57], a[222:223], v[76:79] cbsz:2 abid:2
    s_waitcnt vmcnt(6)
    s_cmp_eq_u32 s63, 0
    s_cbranch_scc0 L_skip145
    s_waitcnt vmcnt(4)
L_skip145:
    s_mov_b32 s52, 0x120000
    buffer_load_dwordx4 a[48:51], v2, s[36:39], s52 offen offset:0 nt
    v_mfma_f32_4x4x4_16b_bf16 v[72:75], v[58:59], a[224:225], v[72:75] cbsz:2 abid:2
    v_mfma_f32_4x4x4_16b_bf16 v[76:79], v[58:59], a[226:227], v[76:79] cbsz:2 abid:2
    s_waitcnt vmcnt(6)
    s_cmp_eq_u32 s63, 0
    s_cbranch_scc0 L_skip146
    s_waitcnt vmcnt(4)
L_skip146:
    s_mov_b32 s52, 0x121000
    buffer_load_dwordx4 a[64:67], v2, s[36:39], s52 offen offset:0 nt
    v_mfma_f32_4x4x4_16b_bf16 v[72:75], v[60:61], a[228:229], v[72:75] cbsz:2 abid:2
    v_mfma_f32_4x4x4_16b_bf16 v[76:79], v[60:61], a[230:231], v[76:79] cbsz:2 abid:2
    s_cmp_eq_u32 s3, 0
    s_cbranch_scc0 L_skip147
    s_waitcnt lgkmcnt(0)
    v_mov_b32 v119, s31
    ds_write_b32 v111, v119
L_skip147:
    s_waitcnt lgkmcnt(0)
    s_barrier
    ds_read_b32 v119, v111
    s_waitcnt vmcnt(6)
    s_cmp_eq_u32 s63, 0
    s_cbranch_scc0 L_skip148
    s_waitcnt vmcnt(4)
L_skip148:
    s_mov_b32 s52, 0x122000
    buffer_load_dwordx4 a[92:95], v2, s[36:39], s52 offen offset:0 nt
    v_mfma_f32_4x4x4_16b_bf16 v[72:75], v[62:63], a[236:237], v[72:75] cbsz:2 abid:2
    v_mfma_f32_4x4x4_16b_bf16 v[76:79], v[62:63], a[238:239], v[76:79] cbsz:2 abid:2
    s_waitcnt lgkmcnt(0)
    v_readfirstlane_b32 s62, v119
    s_nop 1
    s_cmp_ge_i32 s62, 23
    s_cselect_b32 s63, 2, 0
    s_waitcnt vmcnt(6)
    s_cmp_eq_u32 s63, 0
    s_cbranch_scc0 L_skip149
    s_waitcnt vmcnt(4)
L_skip149:
    s_mov_b32 s52, 0x123000
    buffer_load_dwordx4 a[104:107], v2, s[36:39], s52 offen offset:0 nt
    v_mfma_f32_4x4x4_16b_bf16 v[72:75], v[56:57], a[240:241], v[72:75] cbsz:2 abid:3
    v_mfma_f32_4x4x4_16b_bf16 v[76:79], v[56:57], a[242:243], v[76:79] cbsz:2 abid:3
    s_waitcnt vmcnt(6)
    s_cmp_eq_u32 s63, 0
    s_cbranch_scc0 L_skip150
    s_waitcnt vmcnt(4)
L_skip150:
    s_mov_b32 s52, 0x124000
    buffer_load_dwordx4 a[132:135], v2, s[36:39], s52 offen offset:0 nt
    v_mfma_f32_4x4x4_16b_bf16 v[72:75], v[58:59], a[248:249], v[72:75] cbsz:2 abid:3
    v_mfma_f32_4x4x4_16b_bf16 v[76:79], v[58:59], a[250:251], v[76:79] cbsz:2 abid:3
    s_waitcnt vmcnt(6)
    s_cmp_eq_u32 s63, 0
    s_cbranch_scc0 L_skip151
    s_waitcnt vmcnt(4)
L_skip151:
    s_mov_b32 s52, 0x125000
    buffer_load_dwordx4 a[148:151], v2, s[36:39], s52 offen offset:0 nt
    v_mfma_f32_4x4x4_16b_bf16 v[72:75], v[60:61], a[252:253], v[72:75] cbsz:2 abid:3
    v_mfma_f32_4x4x4_16b_bf16 v[76:79], v[60:61], a[254:255], v[76:79] cbsz:2 abid:3
    s_waitcnt vmcnt(6)
    s_cmp_eq_u32 s63, 0
    s_cbranch_scc0 L_skip152
    s_waitcnt vmcnt(4)
L_skip152:
    s_mov_b32 s52, 0x126000
    buffer_load_dwordx4 a[160:163], v2, s[36:39], s52 offen offset:0 nt
    v_mfma_f32_4x4x4_16b_bf16 v[72:75], v[62:63], a[36:37], v[72:75] cbsz:2 abid:3
    v_mfma_f32_4x4x4_16b_bf16 v[76:79], v[62:63], a[38:39], v[76:79] cbsz:2 abid:3
    s_waitcnt vmcnt(6)
    s_cmp_eq_u32 s63, 0
    s_cbranch_scc0 L_skip153
    s_waitcnt vmcnt(4)
L_skip153:
    s_mov_b32 s52, 0x127000
    buffer_load_dwordx4 a[188:191], v2, s[36:39], s52 offen offset:0 nt
    v_mfma_f32_4x4x4_16b_bf16 v[72:75], v[64:65], a[48:49], v[72:75] cbsz:2 abid:0
    v_mfma_f32_4x4x4_16b_bf16 v[76:79], v[64:65], a[50:51], v[76:79] cbsz:2 abid:0
    v_and_b32_dpp v56, v50, v5 quad_perm:[0,0,0,0] row_mask:0xf bank_mask:0xf
    s_cmp_eq_u32 s3, 0
    s_cbranch_scc0 L_skip154
    s_mov_b32 s31, 1
    s_atomic_add s31, s[60:61], 14336 glc
L_skip154:
    s_waitcnt vmcnt(6)
    s_cmp_eq_u32 s63, 0
    s_cbranch_scc0 L_skip155
    s_waitcnt vmcnt(4)
L_skip155:
    s_mov_b32 s52, 0x130000
    buffer_load_dwordx4 a[204:207], v2, s[36:39], s52 offen offset:0 nt
    v_mfma_f32_4x4x4_16b_bf16 v[72:75], v[66:67], a[64:65], v[72:75] cbsz:2 abid:0
    v_mfma_f32_4x4x4_16b_bf16 v[76:79], v[66:67], a[66:67], v[76:79] cbsz:2 abid:0
    v_and_b32_dpp v57, v50, v6 quad_perm:[0,0,0,0] row_mask:0xf bank_mask:0xf
    s_waitcnt vmcnt(6)
    s_cmp_eq_u32 s63, 0
    s_cbranch_scc0 L_skip156
    s_waitcnt vmcnt(4)
L_skip156:
    s_mov_b32 s52, 0x131000
    buffer_load_dwordx4 a[232:235], v2, s[36:39], s52 offen offset:0 nt
    v_mfma_f32_4x4x4_16b_bf16 v[72:75], v[68:69], a[92:93], v[72:75] cbsz:2 abid:0
    v_mfma_f32_4x4x4_16b_bf16 v[76:79], v[68:69], a[94:95], v[76:79] cbsz:2 abid:0
    v_and_b32_dpp v58, v50, v5 quad_perm:[1,1,1,1] row_mask:0xf bank_mask:0xf
    s_waitcnt vmcnt(6)
    s_cmp_eq_u32 s63, 0
    s_cbranch_scc0 L_skip157
    s_waitcnt vmcnt(4)
L_skip157:
    s_mov_b32 s52, 0x132000
    buffer_load_dwordx4 a[244:247], v2, s[36:39], s52 offen offset:0 nt
    v_mfma_f32_4x4x4_16b_bf16 v[72:75], v[70:71], a[104:105], v[72:75] cbsz:2 abid:0
    v_mfma_f32_4x4x4_16b_bf16 v[76:79], v[70:71], a[106:107], v[76:79] cbsz:2 abid:0
    v_and_b32_dpp v59, v50, v6 quad_perm:[1,1,1,1] row_mask:0xf bank_mask:0xf
    s_waitcnt vmcnt(6)
    s_cmp_eq_u32 s63, 0
    s_cbranch_scc0 L_skip158
    s_waitcnt vmcnt(4)
L_skip158:
    s_mov_b32 s52, 0x133000
    buffer_load_dwordx4 a[20:23], v2, s[36:39], s52 offen offset:0 nt
    v_mfma_f32_4x4x4_16b_bf16 v[72:75], v[64:65], a[132:133], v[72:75] cbsz:2 abid:1
    v_mfma_f32_4x4x4_16b_bf16 v[76:79], v[64:65], a[134:135], v[76:79] cbsz:2 abid:1
    v_and_b32_dpp v60, v50, v5 quad_perm:[2,2,2,2] row_mask:0xf bank_mask:0xf
    s_waitcnt vmcnt(6)
    s_cmp_eq_u32 s63, 0
    s_cbranch_scc0 L_skip159
    s_waitcnt vmcnt(4)
L_skip159:
    s_mov_b32 s52, 0x134000
    buffer_load_dwordx4 a[76:79], v2, s[36:39], s52 offen offset:0 nt
    v_mfma_f32_4x4x4_16b_bf16 v[72:75], v[66:67], a[148:149], v[72:75] cbsz:2 abid:1
    v_mfma_f32_4x4x4_16b_bf16 v[76:79], v[66:67], a[150:151], v[76:79] cbsz:2 abid:1
    v_and_b32_dpp v61, v50, v6 quad_perm:[2,2,2,2] row_mask:0xf bank_mask:0xf
    s_waitcnt vmcnt(6)
    s_cmp_eq_u32 s63, 0
    s_cbranch_scc0 L_skip160
    s_waitcnt vmcnt(4)
L_skip160:
    s_mov_b32 s52, 0x135000
    buffer_load_dwordx4 a[120:123], v2, s[36:39], s52 offen offset:0 nt
    v_mfma_f32_4x4x4_16b_bf16 v[72:75], v[68:69], a[160:161], v[72:75] cbsz:2 abid:1
    v_mfma_f32_4x4x4_16b_bf16 v[76:79], v[68:69], a[162:163], v[76:79] cbsz:2 abid:1
    v_and_b32_dpp v62, v50, v5 quad_perm:[3,3,3,3] row_mask:0xf bank_mask:0xf
    s_waitcnt vmcnt(6)
    s_cmp_eq_u32 s63, 0
    s_cbranch_scc0 L_skip161
    s_waitcnt vmcnt(4)
L_skip161:
    s_mov_b32 s52, 0x136000
    buffer_load_dwordx4 a[176:179], v2, s[36:39], s52 offen offset:0 nt
    v_mfma_f32_4x4x4_16b_bf16 v[72:75], v[70:71], a[188:189], v[72:75] cbsz:2 abid:1
    v_mfma_f32_4x4x4_16b_bf16 v[76:79], v[70:71], a[190:191], v[76:79] cbsz:2 abid:1
    v_and_b32_dpp v63, v50, v6 quad_perm:[3,3,3,3] row_mask:0xf bank_mask:0xf
    s_waitcnt vmcnt(6)
    s_cmp_eq_u32 s63, 0
    s_cbranch_scc0 L_skip162
    s_waitcnt vmcnt(4)
L_skip162:
    s_mov_b32 s52, 0x137000
    buffer_load_dwordx4 a[216:219], v2, s[36:39], s52 offen offset:0 nt
    v_mfma_f32_4x4x4_16b_bf16 v[72:75], v[64:65], a[204:205], v[72:75] cbsz:2 abid:2
    v_mfma_f32_4x4x4_16b_bf16 v[76:79], v[64:65], a[206:207], v[76:79] cbsz:2 abid:2
    s_waitcnt vmcnt(6)
    s_cmp_eq_u32 s63, 0
    s_cbranch_scc0 L_skip163
    s_waitcnt vmcnt(4)
L_skip163:
    s_mov_b32 s52, 0x140000
    buffer_load_dwordx4 a[0:3], v2, s[36:39], s52 offen offset:0 nt
    v_mfma_f32_4x4x4_16b_bf16 v[72:75], v[66:67], a[232:233], v[72:75] cbsz:2 abid:2
    v_mfma_f32_4x4x4_16b_bf16 v[76:79], v[66:67], a[234:235], v[76:79] cbsz:2 abid:2
    s_waitcnt vmcnt(6)
    s_cmp_eq_u32 s63, 0
    s_cbranch_scc0 L_skip164
    s_waitcnt vmcnt(4)
L_skip164:
    s_mov_b32 s52, 0x141000
    buffer_load_dwordx4 a[4:7], v2, s[36:39], s52 offen offset:0 nt
    v_mfma_f32_4x4x4_16b_bf16 v[72:75], v[68:69], a[244:245], v[72:75] cbsz:2 abid:2
    v_mfma_f32_4x4x4_16b_bf16 v[76:79], v[68:69], a[246:247], v[76:79] cbsz:2 abid:2
    s_cmp_eq_u32 s3, 0
    s_cbranch_scc0 L_skip165
    s_waitcnt lgkmcnt(0)
    v_mov_b32 v119, s31
    ds_write_b32 v111, v119
L_skip165:
    s_waitcnt lgkmcnt(0)
    s_barrier
    ds_read_b32 v119, v111
    s_waitcnt vmcnt(6)
    s_cmp_eq_u32 s63, 0
    s_cbranch_scc0 L_skip166
    s_waitcnt vmcnt(4)
L_skip166:
    s_mov_b32 s52, 0x142000
    buffer_load_dwordx4 a[8:11], v2, s[36:39], s52 offen offset:0 nt
    v_mfma_f32_4x4x4_16b_bf16 v[72:75], v[70:71], a[20:21], v[72:75] cbsz:2 abid:2
    v_mfma_f32_4x4x4_16b_bf16 v[76:79], v[70:71], a[22:23], v[76:79] cbsz:2 abid:2
    s_waitcnt lgkmcnt(0)
    v_readfirstlane_b32 s62, v119
    s_nop 1
    s_cmp_ge_i32 s62, 23
    s_cselect_b32 s63, 2, 0
    s_waitcnt vmcnt(6)
    s_cmp_eq_u32 s63, 0
    s_cbranch_scc0 L_skip167
    s_waitcnt vmcnt(4)
L_skip167:
    s_mov_b32 s52, 0x143000
    buffer_load_dwordx4 a[12:15], v2, s[36:39], s52 offen offset:0 nt
    v_mfma_f32_4x4x4_16b_bf16 v[72:75], v[64:65], a[76:77], v[72:75] cbsz:2 abid:3
    v_mfma_f32_4x4x4_16b_bf16 v[76:79], v[64:65], a[78:79], v[76:79] cbsz:2 abid:3
    s_waitcnt vmcnt(6)
    s_cmp_eq_u32 s63, 0
    s_cbranch_scc0 L_skip168
    s_waitcnt vmcnt(4)
L_skip168:
    s_mov_b32 s52, 0x144000
    buffer_load_dwordx4 a[16:19], v2, s[36:39], s52 offen offset:0 nt
    v_mfma_f32_4x4x4_16b_bf16 v[72:75], v[66:67], a[120:121], v[72:75] cbsz:2 abid:3
    v_mfma_f32_4x4x4_16b_bf16 v[76:79], v[66:67], a[122:123], v[76:79] cbsz:2 abid:3
    s_waitcnt vmcnt(6)
    s_cmp_eq_u32 s63, 0
    s_cbranch_scc0 L_skip169
    s_waitcnt vmcnt(4)
L_skip169:
    s_mov_b32 s52, 0x145000
    buffer_load_dwordx4 a[24:27], v2, s[36:39], s52 offen offset:0 nt
    v_mfma_f32_4x4x4_16b_bf16 v[72:75], v[68:69], a[176:177], v[72:75] cbsz:2 abid:3
    v_mfma_f32_4x4x4_16b_bf16 v[76:79], v[68:69], a[178:179], v[76:79] cbsz:2 abid:3
    s_waitcnt vmcnt(6)
    s_cmp_eq_u32 s63, 0
    s_cbranch_scc0 L_skip170
    s_waitcnt vmcnt(4)
L_skip170:
    s_mov_b32 s52, 0x146000
    buffer_load_dwordx4 a[28:31], v2, s[36:39], s52 offen offset:0 nt
    v_mfma_f32_4x4x4_16b_bf16 v[72:75], v[70:71], a[216:217], v[72:75] cbsz:2 abid:3
    v_mfma_f32_4x4x4_16b_bf16 v[76:79], v[70:71], a[218:219], v[76:79] cbsz:2 abid:3
    s_waitcnt vmcnt(6)
    s_cmp_eq_u32 s63, 0
    s_cbranch_scc0 L_skip171
    s_waitcnt vmcnt(4)
L_skip171:
    s_mov_b32 s52, 0x147000
    buffer_load_dwordx4 a[32:35], v2, s[36:39], s52 offen offset:0 nt
    v_mfma_f32_4x4x4_16b_bf16 v[72:75], v[56:57], a[0:1], v[72:75] cbsz:2 abid:0
    v_mfma_f32_4x4x4_16b_bf16 v[76:79], v[56:57], a[2:3], v[76:79] cbsz:2 abid:0
    v_and_b32_dpp v64, v51, v5 quad_perm:[0,0,0,0] row_mask:0xf bank_mask:0xf
    s_cmp_eq_u32 s3, 0
    s_cbranch_scc0 L_skip172
    s_mov_b32 s31, 1
    s_atomic_add s31, s[60:61], 16384 glc
L_skip172:
    s_waitcnt vmcnt(6)
    s_cmp_eq_u32 s63, 0
    s_cbranch_scc0 L_skip173
    s_waitcnt vmcnt(4)
L_skip173:
    s_mov_b32 s52, 0x150000
    buffer_load_dwordx4 a[40:43], v2, s[36:39], s52 offen offset:0 nt
    v_mfma_f32_4x4x4_16b_bf16 v[72:75], v[58:59], a[4:5], v[72:75] cbsz:2 abid:0
    v_mfma_f32_4x4x4_16b_bf16 v[76:79], v[58:59], a[6:7], v[76:79] cbsz:2 abid:0
    v_and_b32_dpp v65, v51, v6 quad_perm:[0,0,0,0] row_mask:0xf bank_mask:0xf
    s_waitcnt vmcnt(6)
    s_cmp_eq_u32 s63, 0
    s_cbranch_scc0 L_skip174
    s_waitcnt vmcnt(4)
L_skip174:
    s_mov_b32 s52, 0x151000
    buffer_load_dwordx4 a[44:47], v2, s[36:39], s52 offen offset:0 nt
    v_mfma_f32_4x4x4_16b_bf16 v[72:75], v[60:61], a[8:9], v[72:75] cbsz:2 abid:0
    v_mfma_f32_4x4x4_16b_bf16 v[76:79], v[60:61], a[10:11], v[76:79] cbsz:2 abid:0
    v_and_b32_dpp v66, v51, v5 quad_perm:[1,1,1,1] row_mask:0xf bank_mask:0xf
    s_waitcnt vmcnt(6)
    s_cmp_eq_u32 s63, 0
    s_cbranch_scc0 L_skip175
    s_waitcnt vmcnt(4)
L_skip175:
    s_mov_b32 s52, 0x152000
    buffer_load_dwordx4 a[52:55], v2, s[36:39], s52 offen offset:0 nt
    v_mfma_f32_4x4x4_16b_bf16 v[72:75], v[62:63], a[12:13], v[72:75] cbsz:2 abid:0
    v_mfma_f32_4x4x4_16b_bf16 v[76:79], v[62:63], a[14:15], v[76:79] cbsz:2 abid:0
    v_and_b32_dpp v67, v51, v6 quad_perm:[1,1,1,1] row_mask:0xf bank_mask:0xf
    s_waitcnt vmcnt(6)
    s_cmp_eq_u32 s63, 0
    s_cbranch_scc0 L_skip176
    s_waitcnt vmcnt(4)
L_skip176:
    s_mov_b32 s52, 0x153000
    buffer_load_dwordx4 a[56:59], v2, s[36:39], s52 offen offset:0 nt
    v_mfma_f32_4x4x4_16b_bf16 v[72:75], v[56:57], a[16:17], v[72:75] cbsz:2 abid:1
    v_mfma_f32_4x4x4_16b_bf16 v[76:79], v[56:57], a[18:19], v[76:79] cbsz:2 abid:1
    v_and_b32_dpp v68, v51, v5 quad_perm:[2,2,2,2] row_mask:0xf bank_mask:0xf
    s_waitcnt vmcnt(6)
    s_cmp_eq_u32 s63, 0
    s_cbranch_scc0 L_skip177
    s_waitcnt vmcnt(4)
L_skip177:
    s_mov_b32 s52, 0x154000
    buffer_load_dwordx4 a[60:63], v2, s[36:39], s52 offen offset:0 nt
    v_mfma_f32_4x4x4_16b_bf16 v[72:75], v[58:59], a[24:25], v[72:75] cbsz:2 abid:1
    v_mfma_f32_4x4x4_16b_bf16 v[76:79], v[58:59], a[26:27], v[76:79] cbsz:2 abid:1
    v_and_b32_dpp v69, v51, v6 quad_perm:[2,2,2,2] row_mask:0xf bank_mask:0xf
    s_waitcnt vmcnt(6)
    s_cmp_eq_u32 s63, 0
    s_cbranch_scc0 L_skip178
    s_waitcnt vmcnt(4)
L_skip178:
    s_mov_b32 s52, 0x155000
    buffer_load_dwordx4 a[68:71], v2, s[36:39], s52 offen offset:0 nt
    v_mfma_f32_4x4x4_16b_bf16 v[72:75], v[60:61], a[28:29], v[72:75] cbsz:2 abid:1
    v_mfma_f32_4x4x4_16b_bf16 v[76:79], v[60:61], a[30:31], v[76:79] cbsz:2 abid:1
    v_and_b32_dpp v70, v51, v5 quad_perm:[3,3,3,3] row_mask:0xf bank_mask:0xf
    s_waitcnt vmcnt(6)
    s_cmp_eq_u32 s63, 0
    s_cbranch_scc0 L_skip179
    s_waitcnt vmcnt(4)
L_skip179:
    s_mov_b32 s52, 0x156000
    buffer_load_dwordx4 a[72:75], v2, s[36:39], s52 offen offset:0 nt
    v_mfma_f32_4x4x4_16b_bf16 v[72:75], v[62:63], a[32:33], v[72:75] cbsz:2 abid:1
    v_mfma_f32_4x4x4_16b_bf16 v[76:79], v[62:63], a[34:35], v[76:79] cbsz:2 abid:1
    v_and_b32_dpp v71, v51, v6 quad_perm:[3,3,3,3] row_mask:0xf bank_mask:0xf
    s_waitcnt vmcnt(6)
    s_cmp_eq_u32 s63, 0
    s_cbranch_scc0 L_skip180
    s_waitcnt vmcnt(4)
L_skip180:
    s_mov_b32 s52, 0x157000
    buffer_load_dwordx4 a[80:83], v2, s[36:39], s52 offen offset:0 nt
    v_mfma_f32_4x4x4_16b_bf16 v[72:75], v[56:57], a[40:41], v[72:75] cbsz:2 abid:2
    v_mfma_f32_4x4x4_16b_bf16 v[76:79], v[56:57], a[42:43], v[76:79] cbsz:2 abid:2
    s_waitcnt vmcnt(6)
    s_cmp_eq_u32 s63, 0
    s_cbranch_scc0 L_skip181
    s_waitcnt vmcnt(4)
L_skip181:
    s_mov_b32 s52, 0x160000
    buffer_load_dwordx4 a[84:87], v2, s[36:39], s52 offen offset:0 nt
    v_mfma_f32_4x4x4_16b_bf16 v[72:75], v[58:59], a[44:45], v[72:75] cbsz:2 abid:2
    v_mfma_f32_4x4x4_16b_bf16 v[76:79], v[58:59], a[46:47], v[76:79] cbsz:2 abid:2
    s_waitcnt vmcnt(6)
    s_cmp_eq_u32 s63, 0
    s_cbranch_scc0 L_skip182
    s_waitcnt vmcnt(4)
L_skip182:
    s_mov_b32 s52, 0x161000
    buffer_load_dwordx4 a[88:91], v2, s[36:39], s52 offen offset:0 nt
    v_mfma_f32_4x4x4_16b_bf16 v[72:75], v[60:61], a[52:53], v[72:75] cbsz:2 abid:2
    v_mfma_f32_4x4x4_16b_bf16 v[76:79], v[60:61], a[54:55], v[76:79] cbsz:2 abid:2
    s_cmp_eq_u32 s3, 0
    s_cbranch_scc0 L_skip183
    s_waitcnt lgkmcnt(0)
    v_mov_b32 v119, s31
    ds_write_b32 v111, v119
L_skip183:
    s_waitcnt lgkmcnt(0)
    s_barrier
    ds_read_b32 v119, v111
    s_waitcnt vmcnt(6)
    s_cmp_eq_u32 s63, 0
    s_cbranch_scc0 L_skip184
    s_waitcnt vmcnt(4)
L_skip184:
    s_mov_b32 s52, 0x162000
    buffer_load_dwordx4 a[96:99], v2, s[36:39], s52 offen offset:0 nt
    v_mfma_f32_4x4x4_16b_bf16 v[72:75], v[62:63], a[56:57], v[72:75] cbsz:2 abid:2
    v_mfma_f32_4x4x4_16b_bf16 v[76:79], v[62:63], a[58:59], v[76:79] cbsz:2 abid:2
    s_waitcnt lgkmcnt(0)
    v_readfirstlane_b32 s62, v119
    s_nop 1
    s_cmp_ge_i32 s62, 23
    s_cselect_b32 s63, 2, 0
    s_waitcnt vmcnt(6)
    s_cmp_eq_u32 s63, 0
    s_cbranch_scc0 L_skip185
    s_waitcnt vmcnt(4)
L_skip185:
    s_mov_b32 s52, 0x163000
    buffer_load_dwordx4 a[100:103], v2, s[36:39], s52 offen offset:0 nt
    v_mfma_f32_4x4x4_16b_bf16 v[72:75], v[56:57], a[60:61], v[72:75] cbsz:2 abid:3
    v_mfma_f32_4x4x4_16b_bf16 v[76:79], v[56:57], a[62:63], v[76:79] cbsz:2 abid:3
    s_waitcnt vmcnt(6)
    s_cmp_eq_u32 s63, 0
    s_cbranch_scc0 L_skip186
    s_waitcnt vmcnt(4)
L_skip186:
    s_mov_b32 s52, 0x164000
    buffer_load_dwordx4 a[108:111], v2, s[36:39], s52 offen offset:0 nt
    v_mfma_f32_4x4x4_16b_bf16 v[72:75], v[58:59], a[68:69], v[72:75] cbsz:2 abid:3
    v_mfma_f32_4x4x4_16b_bf16 v[76:79], v[58:59], a[70:71], v[76:79] cbsz:2 abid:3
    s_waitcnt vmcnt(6)
    s_cmp_eq_u32 s63, 0
    s_cbranch_scc0 L_skip187
    s_waitcnt vmcnt(4)
L_skip187:
    s_mov_b32 s52, 0x165000
    buffer_load_dwordx4 a[112:115], v2, s[36:39], s52 offen offset:0 nt
    v_mfma_f32_4x4x4_16b_bf16 v[72:75], v[60:61], a[72:73], v[72:75] cbsz:2 abid:3
    v_mfma_f32_4x4x4_16b_bf16 v[76:79], v[60:61], a[74:75], v[76:79] cbsz:2 abid:3
    s_waitcnt vmcnt(6)
    s_cmp_eq_u32 s63, 0
    s_cbranch_scc0 L_skip188
    s_waitcnt vmcnt(4)
L_skip188:
    s_mov_b32 s52, 0x166000
    buffer_load_dwordx4 a[116:119], v2, s[36:39], s52 offen offset:0 nt
    v_mfma_f32_4x4x4_16b_bf16 v[72:75], v[62:63], a[80:81], v[72:75] cbsz:2 abid:3
    v_mfma_f32_4x4x4_16b_bf16 v[76:79], v[62:63], a[82:83], v[76:79] cbsz:2 abid:3
    s_waitcnt vmcnt(6)
    s_cmp_eq_u32 s63, 0
    s_cbranch_scc0 L_skip189
    s_waitcnt vmcnt(4)
L_skip189:
    s_mov_b32 s52, 0x167000
    buffer_load_dwordx4 a[124:127], v2, s[36:39], s52 offen offset:0 nt
    v_mfma_f32_4x4x4_16b_bf16 v[72:75], v[64:65], a[84:85], v[72:75] cbsz:2 abid:0
    v_mfma_f32_4x4x4_16b_bf16 v[76:79], v[64:65], a[86:87], v[76:79] cbsz:2 abid:0
    v_and_b32_dpp v56, v52, v5 quad_perm:[0,0,0,0] row_mask:0xf bank_mask:0xf
    s_cmp_eq_u32 s3, 0
    s_cbranch_scc0 L_skip190
    s_mov_b32 s31, 1
    s_atomic_add s31, s[60:61], 18432 glc
L_skip190:
    s_waitcnt vmcnt(6)
    s_cmp_eq_u32 s63, 0
    s_cbranch_scc0 L_skip191
    s_waitcnt vmcnt(4)
L_skip191:
    s_mov_b32 s52, 0x170000
    buffer_load_dwordx4 a[128:131], v2, s[36:39], s52 offen offset:0 nt
    s_lshl_b32 s55, s3, 12
    s_add_u32 s56, s55, 0x80000
    v_lshlrev_b32 v102, 6, v0
    v_add_u32 v102, s56, v102
    s_lshl_b32 s56, s2, 14
    s_or_b32 s55, s55, s56
    v_lshrrev_b32 v105, 2, v0
    v_lshlrev_b32 v105, 8, v105
    v_and_b32 v106, 3, v0
    v_lshl_or_b32 v105, v106, 4, v105
    v_or_b32 v105, s55, v105
    s_lshl_b32 s55, s2, 9
    s_add_u32 s55, s55, 0x80008
    v_bfe_u32 v103, v0, 1, 3
    v_lshlrev_b32 v103, 6, v103
    v_and_b32 v106, 1, v0
    v_lshl_or_b32 v103, v106, 3, v103
    v_add_u32 v103, s55, v103
    s_lshl_b32 s55, s2, 5
    v_and_b32 v104, 15, v0
    v_lshlrev_b32 v104, 1, v104
    v_or_b32 v104, s55, v104
    v_mov_b32 v106, 0
    v_and_b32 v90, 3, v0
    v_mov_b32 v89, 0xffff
    v_and_b32 v88, 2, v0
    v_lshlrev_b32 v88, 3, v88
    v_lshlrev_b32 v89, v88, v89
    v_or_b32 v91, 12, v90
    v_lshlrev_b32 v88, 2, v90
    v_cmp_gt_u32 vcc, 2, v90
    s_nop 1
    v_cndmask_b32 v90, v88, v91, vcc
    v_mul_u32_u24 v90, 0x1111, v90
    v_bfe_u32 v91, v0, 2, 2
    v_cmp_eq_u32 vcc, 0, v91
    s_nop 1
    v_cndmask_b32 v88, 0, v89, vcc
    v_cmp_eq_u32 vcc, 1, v91
    s_nop 1
    v_cndmask_b32 v89, 0, v89, vcc
    v_and_b32 v91, 0x1ff, v127
    v_bfe_u32 v7, v0, 4, 1
    v_and_b32 v126, 0xffffffe7, v126
    v_lshl_or_b32 v126, v7, 4, v126
    v_mov_b32 v24, 0
    v_mov_b32 v25, 0
    v_mov_b32 v26, 0
    v_mov_b32 v27, 0
    s_cmp_lt_u32 s2, 32
    s_cbranch_scc0 L_skip192
    global_load_dwordx2 v[96:97], v102, s[28:29] sc1
    global_load_dwordx2 v[98:99], v103, s[28:29] sc1
    global_load_ushort v100, v104, s[4:5]
    global_load_ushort v101, v106, s[22:23]
L_skip192:
    v_mfma_f32_4x4x4_16b_bf16 v[72:75], v[66:67], a[88:89], v[72:75] cbsz:2 abid:0
    v_mfma_f32_4x4x4_16b_bf16 v[76:79], v[66:67], a[90:91], v[76:79] cbsz:2 abid:0
    v_and_b32_dpp v57, v52, v6 quad_perm:[0,0,0,0] row_mask:0xf bank_mask:0xf
    s_waitcnt vmcnt(6)
    s_cmp_eq_u32 s63, 0
    s_cbranch_scc0 L_skip193
    s_waitcnt vmcnt(4)
L_skip193:
    s_mov_b32 s52, 0x171000
    buffer_load_dwordx4 a[136:139], v2, s[36:39], s52 offen offset:0 nt
    v_mfma_f32_4x4x4_16b_bf16 v[72:75], v[68:69], a[96:97], v[72:75] cbsz:2 abid:0
    v_mfma_f32_4x4x4_16b_bf16 v[76:79], v[68:69], a[98:99], v[76:79] cbsz:2 abid:0
    v_and_b32_dpp v58, v52, v5 quad_perm:[1,1,1,1] row_mask:0xf bank_mask:0xf
    s_waitcnt vmcnt(6)
    s_cmp_eq_u32 s63, 0
    s_cbranch_scc0 L_skip194
    s_waitcnt vmcnt(4)
L_skip194:
    s_mov_b32 s52, 0x172000
    buffer_load_dwordx4 a[140:143], v2, s[36:39], s52 offen offset:0 nt
    v_mfma_f32_4x4x4_16b_bf16 v[72:75], v[70:71], a[100:101], v[72:75] cbsz:2 abid:0
    v_mfma_f32_4x4x4_16b_bf16 v[76:79], v[70:71], a[102:103], v[76:79] cbsz:2 abid:0
    v_and_b32_dpp v59, v52, v6 quad_perm:[1,1,1,1] row_mask:0xf bank_mask:0xf
    s_waitcnt vmcnt(6)
    s_cmp_eq_u32 s63, 0
    s_cbranch_scc0 L_skip195
    s_waitcnt vmcnt(4)
L_skip195:
    s_mov_b32 s52, 0x173000
    buffer_load_dwordx4 a[144:147], v2, s[36:39], s52 offen offset:0 nt
    v_mfma_f32_4x4x4_16b_bf16 v[72:75], v[64:65], a[108:109], v[72:75] cbsz:2 abid:1
    v_mfma_f32_4x4x4_16b_bf16 v[76:79], v[64:65], a[110:111], v[76:79] cbsz:2 abid:1
    v_and_b32_dpp v60, v52, v5 quad_perm:[2,2,2,2] row_mask:0xf bank_mask:0xf
    s_waitcnt vmcnt(6)
    s_cmp_eq_u32 s63, 0
    s_cbranch_scc0 L_skip196
    s_waitcnt vmcnt(4)
L_skip196:
    s_mov_b32 s52, 0x174000
    buffer_load_dwordx4 a[152:155], v2, s[36:39], s52 offen offset:0 nt
    v_mfma_f32_4x4x4_16b_bf16 v[72:75], v[66:67], a[112:113], v[72:75] cbsz:2 abid:1
    v_mfma_f32_4x4x4_16b_bf16 v[76:79], v[66:67], a[114:115], v[76:79] cbsz:2 abid:1
    v_and_b32_dpp v61, v52, v6 quad_perm:[2,2,2,2] row_mask:0xf bank_mask:0xf
    s_waitcnt vmcnt(6)
    s_cmp_eq_u32 s63, 0
    s_cbranch_scc0 L_skip197
    s_waitcnt vmcnt(4)
L_skip197:
    s_mov_b32 s52, 0x175000
    buffer_load_dwordx4 a[156:159], v2, s[36:39], s52 offen offset:0 nt
    v_mfma_f32_4x4x4_16b_bf16 v[72:75], v[68:69], a[116:117], v[72:75] cbsz:2 abid:1
    v_mfma_f32_4x4x4_16b_bf16 v[76:79], v[68:69], a[118:119], v[76:79] cbsz:2 abid:1
    v_and_b32_dpp v62, v52, v5 quad_perm:[3,3,3,3] row_mask:0xf bank_mask:0xf
    s_waitcnt vmcnt(6)
    s_cmp_eq_u32 s63, 0
    s_cbranch_scc0 L_skip198
    s_waitcnt vmcnt(4)
L_skip198:
    s_mov_b32 s52, 0x176000
    buffer_load_dwordx4 a[164:167], v2, s[36:39], s52 offen offset:0 nt
    v_mfma_f32_4x4x4_16b_bf16 v[72:75], v[70:71], a[124:125], v[72:75] cbsz:2 abid:1
    v_mfma_f32_4x4x4_16b_bf16 v[76:79], v[70:71], a[126:127], v[76:79] cbsz:2 abid:1
    v_and_b32_dpp v63, v52, v6 quad_perm:[3,3,3,3] row_mask:0xf bank_mask:0xf
    s_waitcnt vmcnt(6)
    s_cmp_eq_u32 s63, 0
    s_cbranch_scc0 L_skip199
    s_waitcnt vmcnt(4)
L_skip199:
    s_mov_b32 s52, 0x177000
    buffer_load_dwordx4 a[168:171], v2, s[36:39], s52 offen offset:0 nt
    v_mfma_f32_4x4x4_16b_bf16 v[72:75], v[64:65], a[128:129], v[72:75] cbsz:2 abid:2
    v_mfma_f32_4x4x4_16b_bf16 v[76:79], v[64:65], a[130:131], v[76:79] cbsz:2 abid:2
    s_waitcnt vmcnt(6)
    s_cmp_eq_u32 s63, 0
    s_cbranch_scc0 L_skip200
    s_waitcnt vmcnt(4)
L_skip200:
    s_mov_b32 s52, 0x180000
    buffer_load_dwordx4 a[172:175], v2, s[36:39], s52 offen offset:0 nt
    v_mfma_f32_4x4x4_16b_bf16 v[72:75], v[66:67], a[136:137], v[72:75] cbsz:2 abid:2
    v_mfma_f32_4x4x4_16b_bf16 v[76:79], v[66:67], a[138:139], v[76:79] cbsz:2 abid:2
    s_waitcnt vmcnt(6)
    s_cmp_eq_u32 s63, 0
    s_cbranch_scc0 L_skip201
    s_waitcnt vmcnt(4)
L_skip201:
    s_mov_b32 s52, 0x181000
    buffer_load_dwordx4 a[180:183], v2, s[36:39], s52 offen offset:0 nt
    v_mfma_f32_4x4x4_16b_bf16 v[72:75], v[68:69], a[140:141], v[72:75] cbsz:2 abid:2
    v_mfma_f32_4x4x4_16b_bf16 v[76:79], v[68:69], a[142:143], v[76:79] cbsz:2 abid:2
    s_cmp_eq_u32 s3, 0
    s_cbranch_scc0 L_skip202
    s_waitcnt lgkmcnt(0)
    v_mov_b32 v119, s31
    ds_write_b32 v111, v119
L_skip202:
    s_waitcnt lgkmcnt(0)
    s_barrier
    ds_read_b32 v119, v111
    s_waitcnt vmcnt(6)
    s_cmp_eq_u32 s63, 0
    s_cbranch_scc0 L_skip203
    s_waitcnt vmcnt(4)
L_skip203:
    s_mov_b32 s52, 0x182000
    buffer_load_dwordx4 a[184:187], v2, s[36:39], s52 offen offset:0 nt
    v_mfma_f32_4x4x4_16b_bf16 v[72:75], v[70:71], a[144:145], v[72:75] cbsz:2 abid:2
    v_mfma_f32_4x4x4_16b_bf16 v[76:79], v[70:71], a[146:147], v[76:79] cbsz:2 abid:2
    s_waitcnt lgkmcnt(0)
    v_readfirstlane_b32 s62, v119
    s_nop 1
    s_cmp_ge_i32 s62, 23
    s_cselect_b32 s63, 2, 0
    s_waitcnt vmcnt(6)
    s_cmp_eq_u32 s63, 0
    s_cbranch_scc0 L_skip204
    s_waitcnt vmcnt(4)
L_skip204:
    s_mov_b32 s52, 0x183000
    buffer_load_dwordx4 a[192:195], v2, s[36:39], s52 offen offset:0 nt
    v_mfma_f32_4x4x4_16b_bf16 v[72:75], v[64:65], a[152:153], v[72:75] cbsz:2 abid:3
    v_mfma_f32_4x4x4_16b_bf16 v[76:79], v[64:65], a[154:155], v[76:79] cbsz:2 abid:3
    s_waitcnt vmcnt(6)
    s_cmp_eq_u32 s63, 0
    s_cbranch_scc0 L_skip205
    s_waitcnt vmcnt(4)
L_skip205:
    s_mov_b32 s52, 0x184000
    buffer_load_dwordx4 a[196:199], v2, s[36:39], s52 offen offset:0 nt
    v_mfma_f32_4x4x4_16b_bf16 v[72:75], v[66:67], a[156:157], v[72:75] cbsz:2 abid:3
    v_mfma_f32_4x4x4_16b_bf16 v[76:79], v[66:67], a[158:159], v[76:79] cbsz:2 abid:3
    s_waitcnt vmcnt(6)
    s_cmp_eq_u32 s63, 0
    s_cbranch_scc0 L_skip206
    s_waitcnt vmcnt(4)
L_skip206:
    s_mov_b32 s52, 0x185000
    buffer_load_dwordx4 a[200:203], v2, s[36:39], s52 offen offset:0 nt
    v_mfma_f32_4x4x4_16b_bf16 v[72:75], v[68:69], a[164:165], v[72:75] cbsz:2 abid:3
    v_mfma_f32_4x4x4_16b_bf16 v[76:79], v[68:69], a[166:167], v[76:79] cbsz:2 abid:3
    s_waitcnt vmcnt(6)
    s_cmp_eq_u32 s63, 0
    s_cbranch_scc0 L_skip207
    s_waitcnt vmcnt(4)
L_skip207:
    s_mov_b32 s52, 0x186000
    buffer_load_dwordx4 a[208:211], v2, s[36:39], s52 offen offset:0 nt
    v_mfma_f32_4x4x4_16b_bf16 v[72:75], v[70:71], a[168:169], v[72:75] cbsz:2 abid:3
    v_mfma_f32_4x4x4_16b_bf16 v[76:79], v[70:71], a[170:171], v[76:79] cbsz:2 abid:3
    s_waitcnt vmcnt(6)
    s_cmp_eq_u32 s63, 0
    s_cbranch_scc0 L_skip208
    s_waitcnt vmcnt(4)
L_skip208:
    s_mov_b32 s52, 0x187000
    buffer_load_dwordx4 a[212:215], v2, s[36:39], s52 offen offset:0 nt
    v_mfma_f32_4x4x4_16b_bf16 v[72:75], v[56:57], a[172:173], v[72:75] cbsz:2 abid:0
    v_mfma_f32_4x4x4_16b_bf16 v[76:79], v[56:57], a[174:175], v[76:79] cbsz:2 abid:0
    v_and_b32_dpp v64, v53, v5 quad_perm:[0,0,0,0] row_mask:0xf bank_mask:0xf
    s_cmp_eq_u32 s3, 0
    s_cbranch_scc0 L_skip209
    s_mov_b32 s31, 1
    s_atomic_add s31, s[60:61], 20480 glc
L_skip209:
    s_cmp_eq_u32 s63, 0
    s_cbranch_scc0 L_skip210
    s_waitcnt vmcnt(4)
L_skip210:
    s_mov_b32 s52, 0x190000
    buffer_load_dwordx4 a[220:223], v2, s[36:39], s52 offen offset:0 nt
    s_cmp_eq_u32 s63, 0
    s_cbranch_scc0 L_skip211
    s_waitcnt vmcnt(4)
L_skip211:
    s_mov_b32 s52, 0x191000
    buffer_load_dwordx4 a[224:227], v2, s[36:39], s52 offen offset:0 nt
    s_waitcnt vmcnt(8)
    s_cmp_eq_u32 s63, 0
    s_cbranch_scc0 L_skip212
    s_waitcnt vmcnt(4)
L_skip212:
    s_mov_b32 s52, 0x192000
    buffer_load_dwordx4 a[228:231], v2, s[36:39], s52 offen offset:0 nt
    v_mfma_f32_4x4x4_16b_bf16 v[72:75], v[58:59], a[180:181], v[72:75] cbsz:2 abid:0
    v_mfma_f32_4x4x4_16b_bf16 v[76:79], v[58:59], a[182:183], v[76:79] cbsz:2 abid:0
    v_and_b32_dpp v65, v53, v6 quad_perm:[0,0,0,0] row_mask:0xf bank_mask:0xf
    s_waitcnt vmcnt(8)
    s_cmp_eq_u32 s63, 0
    s_cbranch_scc0 L_skip213
    s_waitcnt vmcnt(4)
L_skip213:
    s_mov_b32 s52, 0x193000
    buffer_load_dwordx4 a[236:239], v2, s[36:39], s52 offen offset:0 nt
    v_mfma_f32_4x4x4_16b_bf16 v[72:75], v[60:61], a[184:185], v[72:75] cbsz:2 abid:0
    v_mfma_f32_4x4x4_16b_bf16 v[76:79], v[60:61], a[186:187], v[76:79] cbsz:2 abid:0
    v_and_b32_dpp v66, v53, v5 quad_perm:[1,1,1,1] row_mask:0xf bank_mask:0xf
    s_waitcnt vmcnt(8)
    s_cmp_eq_u32 s63, 0
    s_cbranch_scc0 L_skip214
    s_waitcnt vmcnt(4)
L_skip214:
    s_mov_b32 s52, 0x194000
    buffer_load_dwordx4 a[240:243], v2, s[36:39], s52 offen offset:0 nt
    v_mfma_f32_4x4x4_16b_bf16 v[72:75], v[62:63], a[192:193], v[72:75] cbsz:2 abid:0
    v_mfma_f32_4x4x4_16b_bf16 v[76:79], v[62:63], a[194:195], v[76:79] cbsz:2 abid:0
    v_and_b32_dpp v67, v53, v6 quad_perm:[1,1,1,1] row_mask:0xf bank_mask:0xf
    s_waitcnt vmcnt(8)
    s_cmp_eq_u32 s63, 0
    s_cbranch_scc0 L_skip215
    s_waitcnt vmcnt(4)
L_skip215:
    s_mov_b32 s52, 0x195000
    buffer_load_dwordx4 a[248:251], v2, s[36:39], s52 offen offset:0 nt
    v_mfma_f32_4x4x4_16b_bf16 v[72:75], v[56:57], a[196:197], v[72:75] cbsz:2 abid:1
    v_mfma_f32_4x4x4_16b_bf16 v[76:79], v[56:57], a[198:199], v[76:79] cbsz:2 abid:1
    v_and_b32_dpp v68, v53, v5 quad_perm:[2,2,2,2] row_mask:0xf bank_mask:0xf
    s_waitcnt vmcnt(8)
    s_cmp_eq_u32 s63, 0
    s_cbranch_scc0 L_skip216
    s_waitcnt vmcnt(4)
L_skip216:
    s_mov_b32 s52, 0x196000
    buffer_load_dwordx4 a[252:255], v2, s[36:39], s52 offen offset:0 nt
    v_mfma_f32_4x4x4_16b_bf16 v[72:75], v[58:59], a[200:201], v[72:75] cbsz:2 abid:1
    v_mfma_f32_4x4x4_16b_bf16 v[76:79], v[58:59], a[202:203], v[76:79] cbsz:2 abid:1
    v_and_b32_dpp v69, v53, v6 quad_perm:[2,2,2,2] row_mask:0xf bank_mask:0xf
    s_waitcnt vmcnt(8)
    s_cmp_eq_u32 s63, 0
    s_cbranch_scc0 L_skip217
    s_waitcnt vmcnt(4)
L_skip217:
    s_mov_b32 s52, 0x197000
    buffer_load_dwordx4 a[36:39], v2, s[36:39], s52 offen offset:0 nt
    v_mfma_f32_4x4x4_16b_bf16 v[72:75], v[60:61], a[208:209], v[72:75] cbsz:2 abid:1
    v_mfma_f32_4x4x4_16b_bf16 v[76:79], v[60:61], a[210:211], v[76:79] cbsz:2 abid:1
    v_and_b32_dpp v70, v53, v5 quad_perm:[3,3,3,3] row_mask:0xf bank_mask:0xf
    s_waitcnt vmcnt(8)
    s_cmp_eq_u32 s63, 0
    s_cbranch_scc0 L_skip218
    s_waitcnt vmcnt(4)
L_skip218:
    s_mov_b32 s52, 0x1a0000
    buffer_load_dwordx4 a[48:51], v2, s[36:39], s52 offen offset:0 nt
    v_mfma_f32_4x4x4_16b_bf16 v[72:75], v[62:63], a[212:213], v[72:75] cbsz:2 abid:1
    v_mfma_f32_4x4x4_16b_bf16 v[76:79], v[62:63], a[214:215], v[76:79] cbsz:2 abid:1
    v_and_b32_dpp v71, v53, v6 quad_perm:[3,3,3,3] row_mask:0xf bank_mask:0xf
    s_waitcnt vmcnt(8)
    s_cmp_eq_u32 s63, 0
    s_cbranch_scc0 L_skip219
    s_waitcnt vmcnt(4)
L_skip219:
    s_mov_b32 s52, 0x1a1000
    buffer_load_dwordx4 a[64:67], v2, s[36:39], s52 offen offset:0 nt
    v_mfma_f32_4x4x4_16b_bf16 v[72:75], v[56:57], a[220:221], v[72:75] cbsz:2 abid:2
    v_mfma_f32_4x4x4_16b_bf16 v[76:79], v[56:57], a[222:223], v[76:79] cbsz:2 abid:2
    s_cmp_eq_u32 s3, 0
    s_cbranch_scc0 L_skip220
    s_waitcnt lgkmcnt(0)
    v_mov_b32 v119, s31
    ds_write_b32 v111, v119
L_skip220:
    s_waitcnt lgkmcnt(0)
    s_barrier
    ds_read_b32 v119, v111
    s_waitcnt vmcnt(8)
    s_cmp_eq_u32 s63, 0
    s_cbranch_scc0 L_skip221
    s_waitcnt vmcnt(4)
L_skip221:
    s_mov_b32 s52, 0x1a2000
    buffer_load_dwordx4 a[92:95], v2, s[36:39], s52 offen offset:0 nt
    v_mfma_f32_4x4x4_16b_bf16 v[72:75], v[58:59], a[224:225], v[72:75] cbsz:2 abid:2
    v_mfma_f32_4x4x4_16b_bf16 v[76:79], v[58:59], a[226:227], v[76:79] cbsz:2 abid:2
    s_waitcnt lgkmcnt(0)
    v_readfirstlane_b32 s62, v119
    s_nop 1
    s_cmp_ge_i32 s62, 23
    s_cselect_b32 s63, 2, 0
    s_waitcnt vmcnt(8)
    s_cmp_eq_u32 s63, 0
    s_cbranch_scc0 L_skip222
    s_waitcnt vmcnt(4)
L_skip222:
    s_mov_b32 s52, 0x1a3000
    buffer_load_dwordx4 a[104:107], v2, s[36:39], s52 offen offset:0 nt
    v_mfma_f32_4x4x4_16b_bf16 v[72:75], v[60:61], a[228:229], v[72:75] cbsz:2 abid:2
    v_mfma_f32_4x4x4_16b_bf16 v[76:79], v[60:61], a[230:231], v[76:79] cbsz:2 abid:2
    s_waitcnt vmcnt(8)
    s_cmp_eq_u32 s63, 0
    s_cbranch_scc0 L_skip223
    s_waitcnt vmcnt(4)
L_skip223:
    s_mov_b32 s52, 0x1a4000
    buffer_load_dwordx4 a[132:135], v2, s[36:39], s52 offen offset:0 nt
    v_mfma_f32_4x4x4_16b_bf16 v[72:75], v[62:63], a[236:237], v[72:75] cbsz:2 abid:2
    v_mfma_f32_4x4x4_16b_bf16 v[76:79], v[62:63], a[238:239], v[76:79] cbsz:2 abid:2
    s_waitcnt vmcnt(8)
    s_cmp_eq_u32 s63, 0
    s_cbranch_scc0 L_skip224
    s_waitcnt vmcnt(4)
L_skip224:
    s_mov_b32 s52, 0x1a5000
    buffer_load_dwordx4 a[148:151], v2, s[36:39], s52 offen offset:0 nt
    v_mfma_f32_4x4x4_16b_bf16 v[72:75], v[56:57], a[240:241], v[72:75] cbsz:2 abid:3
    v_mfma_f32_4x4x4_16b_bf16 v[76:79], v[56:57], a[242:243], v[76:79] cbsz:2 abid:3
    s_waitcnt vmcnt(8)
    s_cmp_eq_u32 s63, 0
    s_cbranch_scc0 L_skip225
    s_waitcnt vmcnt(4)
L_skip225:
    s_mov_b32 s52, 0x1a6000
    buffer_load_dwordx4 a[160:163], v2, s[36:39], s52 offen offset:0 nt
    v_mfma_f32_4x4x4_16b_bf16 v[72:75], v[58:59], a[248:249], v[72:75] cbsz:2 abid:3
    v_mfma_f32_4x4x4_16b_bf16 v[76:79], v[58:59], a[250:251], v[76:79] cbsz:2 abid:3
    s_waitcnt vmcnt(8)
    s_cmp_eq_u32 s63, 0
    s_cbranch_scc0 L_skip226
    s_waitcnt vmcnt(4)
L_skip226:
    s_mov_b32 s52, 0x1a7000
    buffer_load_dwordx4 a[188:191], v2, s[36:39], s52 offen offset:0 nt
    v_mfma_f32_4x4x4_16b_bf16 v[72:75], v[60:61], a[252:253], v[72:75] cbsz:2 abid:3
    v_mfma_f32_4x4x4_16b_bf16 v[76:79], v[60:61], a[254:255], v[76:79] cbsz:2 abid:3
    s_cmp_eq_u32 s3, 0
    s_cbranch_scc0 L_skip227
    s_mov_b32 s31, 1
    s_atomic_add s31, s[60:61], 22528 glc
L_skip227:
    s_waitcnt vmcnt(8)
    s_cmp_eq_u32 s63, 0
    s_cbranch_scc0 L_skip228
    s_waitcnt vmcnt(4)
L_skip228:
    s_mov_b32 s52, 0x1b0000
    buffer_load_dwordx4 a[204:207], v2, s[36:39], s52 offen offset:0 nt
    v_mfma_f32_4x4x4_16b_bf16 v[72:75], v[62:63], a[36:37], v[72:75] cbsz:2 abid:3
    v_mfma_f32_4x4x4_16b_bf16 v[76:79], v[62:63], a[38:39], v[76:79] cbsz:2 abid:3
    s_waitcnt vmcnt(8)
    s_cmp_eq_u32 s63, 0
    s_cbranch_scc0 L_skip229
    s_waitcnt vmcnt(4)
L_skip229:
    s_mov_b32 s52, 0x1b1000
    buffer_load_dwordx4 a[232:235], v2, s[36:39], s52 offen offset:0 nt
    v_mfma_f32_4x4x4_16b_bf16 v[72:75], v[64:65], a[48:49], v[72:75] cbsz:2 abid:0
    v_mfma_f32_4x4x4_16b_bf16 v[76:79], v[64:65], a[50:51], v[76:79] cbsz:2 abid:0
    v_and_b32_dpp v56, v54, v5 quad_perm:[0,0,0,0] row_mask:0xf bank_mask:0xf
    s_waitcnt vmcnt(8)
    s_cmp_eq_u32 s63, 0
    s_cbranch_scc0 L_skip230
    s_waitcnt vmcnt(4)
L_skip230:
    s_mov_b32 s52, 0x1b2000
    buffer_load_dwordx4 a[244:247], v2, s[36:39], s52 offen offset:0 nt
    v_mfma_f32_4x4x4_16b_bf16 v[72:75], v[66:67], a[64:65], v[72:75] cbsz:2 abid:0
    v_mfma_f32_4x4x4_16b_bf16 v[76:79], v[66:67], a[66:67], v[76:79] cbsz:2 abid:0
    v_and_b32_dpp v57, v54, v6 quad_perm:[0,0,0,0] row_mask:0xf bank_mask:0xf
    s_waitcnt vmcnt(8)
    s_cmp_eq_u32 s63, 0
    s_cbranch_scc0 L_skip231
    s_waitcnt vmcnt(4)
L_skip231:
    s_mov_b32 s52, 0x1b3000
    buffer_load_dwordx4 a[20:23], v2, s[36:39], s52 offen offset:0 nt
    v_mfma_f32_4x4x4_16b_bf16 v[72:75], v[68:69], a[92:93], v[72:75] cbsz:2 abid:0
    v_mfma_f32_4x4x4_16b_bf16 v[76:79], v[68:69], a[94:95], v[76:79] cbsz:2 abid:0
    v_and_b32_dpp v58, v54, v5 quad_perm:[1,1,1,1] row_mask:0xf bank_mask:0xf
    s_waitcnt vmcnt(8)
    s_cmp_eq_u32 s63, 0
    s_cbranch_scc0 L_skip232
    s_waitcnt vmcnt(4)
L_skip232:
    s_mov_b32 s52, 0x1b4000
    buffer_load_dwordx4 a[76:79], v2, s[36:39], s52 offen offset:0 nt
    v_mfma_f32_4x4x4_16b_bf16 v[72:75], v[70:71], a[104:105], v[72:75] cbsz:2 abid:0
    v_mfma_f32_4x4x4_16b_bf16 v[76:79], v[70:71], a[106:107], v[76:79] cbsz:2 abid:0
    v_and_b32_dpp v59, v54, v6 quad_perm:[1,1,1,1] row_mask:0xf bank_mask:0xf
    s_waitcnt vmcnt(8)
    s_cmp_eq_u32 s63, 0
    s_cbranch_scc0 L_skip233
    s_waitcnt vmcnt(4)
L_skip233:
    s_mov_b32 s52, 0x1b5000
    buffer_load_dwordx4 a[120:123], v2, s[36:39], s52 offen offset:0 nt
    v_mfma_f32_4x4x4_16b_bf16 v[72:75], v[64:65], a[132:133], v[72:75] cbsz:2 abid:1
    v_mfma_f32_4x4x4_16b_bf16 v[76:79], v[64:65], a[134:135], v[76:79] cbsz:2 abid:1
    v_and_b32_dpp v60, v54, v5 quad_perm:[2,2,2,2] row_mask:0xf bank_mask:0xf
    s_waitcnt vmcnt(8)
    s_cmp_eq_u32 s63, 0
    s_cbranch_scc0 L_skip234
    s_waitcnt vmcnt(4)
L_skip234:
    s_mov_b32 s52, 0x1b6000
    buffer_load_dwordx4 a[176:179], v2, s[36:39], s52 offen offset:0 nt
    v_mfma_f32_4x4x4_16b_bf16 v[72:75], v[66:67], a[148:149], v[72:75] cbsz:2 abid:1
    v_mfma_f32_4x4x4_16b_bf16 v[76:79], v[66:67], a[150:151], v[76:79] cbsz:2 abid:1
    v_and_b32_dpp v61, v54, v6 quad_perm:[2,2,2,2] row_mask:0xf bank_mask:0xf
    s_waitcnt vmcnt(8)
    s_cmp_eq_u32 s63, 0
    s_cbranch_scc0 L_skip235
    s_waitcnt vmcnt(4)
L_skip235:
    s_mov_b32 s52, 0x1b7000
    buffer_load_dwordx4 a[216:219], v2, s[36:39], s52 offen offset:0 nt
    v_mfma_f32_4x4x4_16b_bf16 v[72:75], v[68:69], a[160:161], v[72:75] cbsz:2 abid:1
    v_mfma_f32_4x4x4_16b_bf16 v[76:79], v[68:69], a[162:163], v[76:79] cbsz:2 abid:1
    v_and_b32_dpp v62, v54, v5 quad_perm:[3,3,3,3] row_mask:0xf bank_mask:0xf
    s_waitcnt vmcnt(8)
    s_cmp_eq_u32 s63, 0
    s_cbranch_scc0 L_skip236
    s_waitcnt vmcnt(4)
L_skip236:
    s_mov_b32 s52, 0x1c0000
    buffer_load_dwordx4 a[0:3], v2, s[36:39], s52 offen offset:0 nt
    v_mfma_f32_4x4x4_16b_bf16 v[72:75], v[70:71], a[188:189], v[72:75] cbsz:2 abid:1
    v_mfma_f32_4x4x4_16b_bf16 v[76:79], v[70:71], a[190:191], v[76:79] cbsz:2 abid:1
    v_and_b32_dpp v63, v54, v6 quad_perm:[3,3,3,3] row_mask:0xf bank_mask:0xf
    s_waitcnt vmcnt(8)
    s_cmp_eq_u32 s63, 0
    s_cbranch_scc0 L_skip237
    s_waitcnt vmcnt(4)
L_skip237:
    s_mov_b32 s52, 0x1c1000
    buffer_load_dwordx4 a[4:7], v2, s[36:39], s52 offen offset:0 nt
    v_mfma_f32_4x4x4_16b_bf16 v[72:75], v[64:65], a[204:205], v[72:75] cbsz:2 abid:2
    v_mfma_f32_4x4x4_16b_bf16 v[76:79], v[64:65], a[206:207], v[76:79] cbsz:2 abid:2
    s_cmp_eq_u32 s3, 0
    s_cbranch_scc0 L_skip238
    s_waitcnt lgkmcnt(0)
    v_mov_b32 v119, s31
    ds_write_b32 v111, v119
L_skip238:
    s_waitcnt lgkmcnt(0)
    s_barrier
    ds_read_b32 v119, v111
    s_waitcnt vmcnt(8)
    s_cmp_eq_u32 s63, 0
    s_cbranch_scc0 L_skip239
    s_waitcnt vmcnt(4)
L_skip239:
    s_mov_b32 s52, 0x1c2000
    buffer_load_dwordx4 a[8:11], v2, s[36:39], s52 offen offset:0 nt
    v_mfma_f32_4x4x4_16b_bf16 v[72:75], v[66:67], a[232:233], v[72:75] cbsz:2 abid:2
    v_mfma_f32_4x4x4_16b_bf16 v[76:79], v[66:67], a[234:235], v[76:79] cbsz:2 abid:2
    s_waitcnt lgkmcnt(0)
    v_readfirstlane_b32 s62, v119
    s_nop 1
    s_cmp_ge_i32 s62, 23
    s_cselect_b32 s63, 2, 0
    s_waitcnt vmcnt(8)
    s_cmp_eq_u32 s63, 0
    s_cbranch_scc0 L_skip240
    s_waitcnt vmcnt(4)
L_skip240:
    s_mov_b32 s52, 0x1c3000
    buffer_load_dwordx4 a[12:15], v2, s[36:39], s52 offen offset:0 nt
    v_mfma_f32_4x4x4_16b_bf16 v[72:75], v[68:69], a[244:245], v[72:75] cbsz:2 abid:2
    v_mfma_f32_4x4x4_16b_bf16 v[76:79], v[68:69], a[246:247], v[76:79] cbsz:2 abid:2
    s_waitcnt vmcnt(8)
    s_cmp_eq_u32 s63, 0
    s_cbranch_scc0 L_skip241
    s_waitcnt vmcnt(4)
L_skip241:
    s_mov_b32 s52, 0x1c4000
    buffer_load_dwordx4 a[16:19], v2, s[36:39], s52 offen offset:0 nt
    v_mfma_f32_4x4x4_16b_bf16 v[72:75], v[70:71], a[20:21], v[72:75] cbsz:2 abid:2
    v_mfma_f32_4x4x4_16b_bf16 v[76:79], v[70:71], a[22:23], v[76:79] cbsz:2 abid:2
    s_waitcnt vmcnt(8)
    s_cmp_eq_u32 s63, 0
    s_cbranch_scc0 L_skip242
    s_waitcnt vmcnt(4)
L_skip242:
    s_mov_b32 s52, 0x1c5000
    buffer_load_dwordx4 a[24:27], v2, s[36:39], s52 offen offset:0 nt
    v_mfma_f32_4x4x4_16b_bf16 v[72:75], v[64:65], a[76:77], v[72:75] cbsz:2 abid:3
    v_mfma_f32_4x4x4_16b_bf16 v[76:79], v[64:65], a[78:79], v[76:79] cbsz:2 abid:3
    s_waitcnt vmcnt(8)
    s_cmp_eq_u32 s63, 0
    s_cbranch_scc0 L_skip243
    s_waitcnt vmcnt(4)
L_skip243:
    s_mov_b32 s52, 0x1c6000
    buffer_load_dwordx4 a[28:31], v2, s[36:39], s52 offen offset:0 nt
    v_mfma_f32_4x4x4_16b_bf16 v[72:75], v[66:67], a[120:121], v[72:75] cbsz:2 abid:3
    v_mfma_f32_4x4x4_16b_bf16 v[76:79], v[66:67], a[122:123], v[76:79] cbsz:2 abid:3
    s_waitcnt vmcnt(8)
    s_cmp_eq_u32 s63, 0
    s_cbranch_scc0 L_skip244
    s_waitcnt vmcnt(4)
L_skip244:
    s_mov_b32 s52, 0x1c7000
    buffer_load_dwordx4 a[32:35], v2, s[36:39], s52 offen offset:0 nt
    v_mfma_f32_4x4x4_16b_bf16 v[72:75], v[68:69], a[176:177], v[72:75] cbsz:2 abid:3
    v_mfma_f32_4x4x4_16b_bf16 v[76:79], v[68:69], a[178:179], v[76:79] cbsz:2 abid:3
    s_cmp_eq_u32 s3, 0
    s_cbranch_scc0 L_skip245
    s_mov_b32 s31, 1
    s_atomic_add s31, s[60:61], 24576 glc
L_skip245:
    s_waitcnt vmcnt(8)
    s_cmp_eq_u32 s63, 0
    s_cbranch_scc0 L_skip246
    s_waitcnt vmcnt(4)
L_skip246:
    s_mov_b32 s52, 0x1d0000
    buffer_load_dwordx4 a[40:43], v2, s[36:39], s52 offen offset:0 nt
    v_mfma_f32_4x4x4_16b_bf16 v[72:75], v[70:71], a[216:217], v[72:75] cbsz:2 abid:3
    v_mfma_f32_4x4x4_16b_bf16 v[76:79], v[70:71], a[218:219], v[76:79] cbsz:2 abid:3
    s_waitcnt vmcnt(8)
    s_cmp_eq_u32 s63, 0
    s_cbranch_scc0 L_skip247
    s_waitcnt vmcnt(4)
L_skip247:
    s_mov_b32 s52, 0x1d1000
    buffer_load_dwordx4 a[44:47], v2, s[36:39], s52 offen offset:0 nt
    v_mfma_f32_4x4x4_16b_bf16 v[72:75], v[56:57], a[0:1], v[72:75] cbsz:2 abid:0
    v_mfma_f32_4x4x4_16b_bf16 v[76:79], v[56:57], a[2:3], v[76:79] cbsz:2 abid:0
    v_and_b32_dpp v64, v55, v5 quad_perm:[0,0,0,0] row_mask:0xf bank_mask:0xf
    s_waitcnt vmcnt(8)
    s_cmp_eq_u32 s63, 0
    s_cbranch_scc0 L_skip248
    s_waitcnt vmcnt(4)
L_skip248:
    s_mov_b32 s52, 0x1d2000
    buffer_load_dwordx4 a[52:55], v2, s[36:39], s52 offen offset:0 nt
    v_mfma_f32_4x4x4_16b_bf16 v[72:75], v[58:59], a[4:5], v[72:75] cbsz:2 abid:0
    v_mfma_f32_4x4x4_16b_bf16 v[76:79], v[58:59], a[6:7], v[76:79] cbsz:2 abid:0
    v_and_b32_dpp v65, v55, v6 quad_perm:[0,0,0,0] row_mask:0xf bank_mask:0xf
    s_waitcnt vmcnt(8)
    s_cmp_eq_u32 s63, 0
    s_cbranch_scc0 L_skip249
    s_waitcnt vmcnt(4)
L_skip249:
    s_mov_b32 s52, 0x1d3000
    buffer_load_dwordx4 a[56:59], v2, s[36:39], s52 offen offset:0 nt
    v_mfma_f32_4x4x4_16b_bf16 v[72:75], v[60:61], a[8:9], v[72:75] cbsz:2 abid:0
    v_mfma_f32_4x4x4_16b_bf16 v[76:79], v[60:61], a[10:11], v[76:79] cbsz:2 abid:0
    v_and_b32_dpp v66, v55, v5 quad_perm:[1,1,1,1] row_mask:0xf bank_mask:0xf
    s_waitcnt vmcnt(8)
    s_cmp_eq_u32 s63, 0
    s_cbranch_scc0 L_skip250
    s_waitcnt vmcnt(4)
L_skip250:
    s_mov_b32 s52, 0x1d4000
    buffer_load_dwordx4 a[60:63], v2, s[36:39], s52 offen offset:0 nt
    v_mfma_f32_4x4x4_16b_bf16 v[72:75], v[62:63], a[12:13], v[72:75] cbsz:2 abid:0
    v_mfma_f32_4x4x4_16b_bf16 v[76:79], v[62:63], a[14:15], v[76:79] cbsz:2 abid:0
    v_and_b32_dpp v67, v55, v6 quad_perm:[1,1,1,1] row_mask:0xf bank_mask:0xf
    s_waitcnt vmcnt(8)
    s_cmp_eq_u32 s63, 0
    s_cbranch_scc0 L_skip251
    s_waitcnt vmcnt(4)
L_skip251:
    s_mov_b32 s52, 0x1d5000
    buffer_load_dwordx4 a[68:71], v2, s[36:39], s52 offen offset:0 nt
    v_mfma_f32_4x4x4_16b_bf16 v[72:75], v[56:57], a[16:17], v[72:75] cbsz:2 abid:1
    v_mfma_f32_4x4x4_16b_bf16 v[76:79], v[56:57], a[18:19], v[76:79] cbsz:2 abid:1
    v_and_b32_dpp v68, v55, v5 quad_perm:[2,2,2,2] row_mask:0xf bank_mask:0xf
    s_waitcnt vmcnt(8)
    s_cmp_eq_u32 s63, 0
    s_cbranch_scc0 L_skip252
    s_waitcnt vmcnt(4)
L_skip252:
    s_mov_b32 s52, 0x1d6000
    buffer_load_dwordx4 a[72:75], v2, s[36:39], s52 offen offset:0 nt
    v_mfma_f32_4x4x4_16b_bf16 v[72:75], v[58:59], a[24:25], v[72:75] cbsz:2 abid:1
    v_mfma_f32_4x4x4_16b_bf16 v[76:79], v[58:59], a[26:27], v[76:79] cbsz:2 abid:1
    v_and_b32_dpp v69, v55, v6 quad_perm:[2,2,2,2] row_mask:0xf bank_mask:0xf
    s_waitcnt vmcnt(8)
    s_cmp_eq_u32 s63, 0
    s_cbranch_scc0 L_skip253
    s_waitcnt vmcnt(4)
L_skip253:
    s_mov_b32 s52, 0x1d7000
    buffer_load_dwordx4 a[80:83], v2, s[36:39], s52 offen offset:0 nt
    v_mfma_f32_4x4x4_16b_bf16 v[72:75], v[60:61], a[28:29], v[72:75] cbsz:2 abid:1
    v_mfma_f32_4x4x4_16b_bf16 v[76:79], v[60:61], a[30:31], v[76:79] cbsz:2 abid:1
    v_and_b32_dpp v70, v55, v5 quad_perm:[3,3,3,3] row_mask:0xf bank_mask:0xf
    s_waitcnt vmcnt(8)
    s_cmp_eq_u32 s63, 0
    s_cbranch_scc0 L_skip254
    s_waitcnt vmcnt(4)
L_skip254:
    s_mov_b32 s52, 0x1e0000
    buffer_load_dwordx4 a[84:87], v2, s[36:39], s52 offen offset:0 nt
    v_mfma_f32_4x4x4_16b_bf16 v[72:75], v[62:63], a[32:33], v[72:75] cbsz:2 abid:1
    v_mfma_f32_4x4x4_16b_bf16 v[76:79], v[62:63], a[34:35], v[76:79] cbsz:2 abid:1
    v_and_b32_dpp v71, v55, v6 quad_perm:[3,3,3,3] row_mask:0xf bank_mask:0xf
    s_waitcnt vmcnt(8)
    s_cmp_eq_u32 s63, 0
    s_cbranch_scc0 L_skip255
    s_waitcnt vmcnt(4)
L_skip255:
    s_mov_b32 s52, 0x1e1000
    buffer_load_dwordx4 a[88:91], v2, s[36:39], s52 offen offset:0 nt
    v_mfma_f32_4x4x4_16b_bf16 v[72:75], v[56:57], a[40:41], v[72:75] cbsz:2 abid:2
    v_mfma_f32_4x4x4_16b_bf16 v[76:79], v[56:57], a[42:43], v[76:79] cbsz:2 abid:2
    s_cmp_eq_u32 s3, 0
    s_cbranch_scc0 L_skip256
    s_waitcnt lgkmcnt(0)
    v_mov_b32 v119, s31
    ds_write_b32 v111, v119
L_skip256:
    s_waitcnt lgkmcnt(0)
    s_barrier
    ds_read_b32 v119, v111
    s_waitcnt vmcnt(8)
    s_cmp_eq_u32 s63, 0
    s_cbranch_scc0 L_skip257
    s_waitcnt vmcnt(4)
L_skip257:
    s_mov_b32 s52, 0x1e2000
    buffer_load_dwordx4 a[96:99], v2, s[36:39], s52 offen offset:0 nt
    v_mfma_f32_4x4x4_16b_bf16 v[72:75], v[58:59], a[44:45], v[72:75] cbsz:2 abid:2
    v_mfma_f32_4x4x4_16b_bf16 v[76:79], v[58:59], a[46:47], v[76:79] cbsz:2 abid:2
    s_waitcnt lgkmcnt(0)
    v_readfirstlane_b32 s62, v119
    s_nop 1
    s_cmp_ge_i32 s62, 23
    s_cselect_b32 s63, 2, 0
    s_waitcnt vmcnt(8)
    s_cmp_eq_u32 s63, 0
    s_cbranch_scc0 L_skip258
    s_waitcnt vmcnt(4)
L_skip258:
    s_mov_b32 s52, 0x1e3000
    buffer_load_dwordx4 a[100:103], v2, s[36:39], s52 offen offset:0 nt
    v_mfma_f32_4x4x4_16b_bf16 v[72:75], v[60:61], a[52:53], v[72:75] cbsz:2 abid:2
    v_mfma_f32_4x4x4_16b_bf16 v[76:79], v[60:61], a[54:55], v[76:79] cbsz:2 abid:2
    s_waitcnt vmcnt(8)
    s_cmp_eq_u32 s63, 0
    s_cbranch_scc0 L_skip259
    s_waitcnt vmcnt(4)
L_skip259:
    s_mov_b32 s52, 0x1e4000
    buffer_load_dwordx4 a[108:111], v2, s[36:39], s52 offen offset:0 nt
    v_mfma_f32_4x4x4_16b_bf16 v[72:75], v[62:63], a[56:57], v[72:75] cbsz:2 abid:2
    v_mfma_f32_4x4x4_16b_bf16 v[76:79], v[62:63], a[58:59], v[76:79] cbsz:2 abid:2
    s_waitcnt vmcnt(8)
    s_cmp_eq_u32 s63, 0
    s_cbranch_scc0 L_skip260
    s_waitcnt vmcnt(4)
L_skip260:
    s_mov_b32 s52, 0x1e5000
    buffer_load_dwordx4 a[112:115], v2, s[36:39], s52 offen offset:0 nt
    v_mfma_f32_4x4x4_16b_bf16 v[72:75], v[56:57], a[60:61], v[72:75] cbsz:2 abid:3
    v_mfma_f32_4x4x4_16b_bf16 v[76:79], v[56:57], a[62:63], v[76:79] cbsz:2 abid:3
    s_waitcnt vmcnt(8)
    s_cmp_eq_u32 s63, 0
    s_cbranch_scc0 L_skip261
    s_waitcnt vmcnt(4)
L_skip261:
    s_mov_b32 s52, 0x1e6000
    buffer_load_dwordx4 a[116:119], v2, s[36:39], s52 offen offset:0 nt
    v_mfma_f32_4x4x4_16b_bf16 v[72:75], v[58:59], a[68:69], v[72:75] cbsz:2 abid:3
    v_mfma_f32_4x4x4_16b_bf16 v[76:79], v[58:59], a[70:71], v[76:79] cbsz:2 abid:3
    s_waitcnt vmcnt(8)
    s_cmp_eq_u32 s63, 0
    s_cbranch_scc0 L_skip262
    s_waitcnt vmcnt(4)
L_skip262:
    s_mov_b32 s52, 0x1e7000
    buffer_load_dwordx4 a[124:127], v2, s[36:39], s52 offen offset:0 nt
    v_mfma_f32_4x4x4_16b_bf16 v[72:75], v[60:61], a[72:73], v[72:75] cbsz:2 abid:3
    v_mfma_f32_4x4x4_16b_bf16 v[76:79], v[60:61], a[74:75], v[76:79] cbsz:2 abid:3
    s_mov_b32 s52, 0x1f0000
    buffer_load_dwordx4 a[128:131], v2, s[36:39], s52 offen offset:0 nt
    s_mov_b32 s52, 0x1f1000
    buffer_load_dwordx4 a[136:139], v2, s[36:39], s52 offen offset:0 nt
    s_mov_b32 s52, 0x1f2000
    buffer_load_dwordx4 a[140:143], v2, s[36:39], s52 offen offset:0 nt
    s_mov_b32 s52, 0x1f3000
    buffer_load_dwordx4 a[144:147], v2, s[36:39], s52 offen offset:0 nt
    s_mov_b32 s52, 0x1f4000
    buffer_load_dwordx4 a[152:155], v2, s[36:39], s52 offen offset:0 nt
    s_mov_b32 s52, 0x1f5000
    buffer_load_dwordx4 a[156:159], v2, s[36:39], s52 offen offset:0 nt
    s_mov_b32 s52, 0x1f6000
    buffer_load_dwordx4 a[164:167], v2, s[36:39], s52 offen offset:0 nt
    s_waitcnt vmcnt(15)
    s_mov_b32 s52, 0x1f7000
    buffer_load_dwordx4 a[168:171], v2, s[36:39], s52 offen offset:0 nt
    v_mfma_f32_4x4x4_16b_bf16 v[72:75], v[62:63], a[80:81], v[72:75] cbsz:2 abid:3
    v_mfma_f32_4x4x4_16b_bf16 v[76:79], v[62:63], a[82:83], v[76:79] cbsz:2 abid:3
    s_waitcnt vmcnt(15)
    v_mfma_f32_4x4x4_16b_bf16 v[72:75], v[64:65], a[84:85], v[72:75] cbsz:2 abid:0
    v_mfma_f32_4x4x4_16b_bf16 v[76:79], v[64:65], a[86:87], v[76:79] cbsz:2 abid:0
    s_waitcnt vmcnt(14)
    v_mfma_f32_4x4x4_16b_bf16 v[72:75], v[66:67], a[88:89], v[72:75] cbsz:2 abid:0
    v_mfma_f32_4x4x4_16b_bf16 v[76:79], v[66:67], a[90:91], v[76:79] cbsz:2 abid:0
    s_waitcnt vmcnt(13)
    v_mfma_f32_4x4x4_16b_bf16 v[72:75], v[68:69], a[96:97], v[72:75] cbsz:2 abid:0
    v_mfma_f32_4x4x4_16b_bf16 v[76:79], v[68:69], a[98:99], v[76:79] cbsz:2 abid:0
    s_waitcnt vmcnt(12)
    v_mfma_f32_4x4x4_16b_bf16 v[72:75], v[70:71], a[100:101], v[72:75] cbsz:2 abid:0
    v_mfma_f32_4x4x4_16b_bf16 v[76:79], v[70:71], a[102:103], v[76:79] cbsz:2 abid:0
    s_waitcnt vmcnt(11)
    v_mfma_f32_4x4x4_16b_bf16 v[72:75], v[64:65], a[108:109], v[72:75] cbsz:2 abid:1
    v_mfma_f32_4x4x4_16b_bf16 v[76:79], v[64:65], a[110:111], v[76:79] cbsz:2 abid:1
    s_waitcnt vmcnt(10)
    v_mfma_f32_4x4x4_16b_bf16 v[72:75], v[66:67], a[112:113], v[72:75] cbsz:2 abid:1
    v_mfma_f32_4x4x4_16b_bf16 v[76:79], v[66:67], a[114:115], v[76:79] cbsz:2 abid:1
    s_waitcnt vmcnt(9)
    v_mfma_f32_4x4x4_16b_bf16 v[72:75], v[68:69], a[116:117], v[72:75] cbsz:2 abid:1
    v_mfma_f32_4x4x4_16b_bf16 v[76:79], v[68:69], a[118:119], v[76:79] cbsz:2 abid:1
    s_waitcnt vmcnt(8)
    v_mfma_f32_4x4x4_16b_bf16 v[72:75], v[70:71], a[124:125], v[72:75] cbsz:2 abid:1
    v_mfma_f32_4x4x4_16b_bf16 v[76:79], v[70:71], a[126:127], v[76:79] cbsz:2 abid:1
    s_waitcnt vmcnt(7)
    v_mfma_f32_4x4x4_16b_bf16 v[72:75], v[64:65], a[128:129], v[72:75] cbsz:2 abid:2
    v_mfma_f32_4x4x4_16b_bf16 v[76:79], v[64:65], a[130:131], v[76:79] cbsz:2 abid:2
    s_waitcnt vmcnt(6)
    v_mfma_f32_4x4x4_16b_bf16 v[72:75], v[66:67], a[136:137], v[72:75] cbsz:2 abid:2
    v_mfma_f32_4x4x4_16b_bf16 v[76:79], v[66:67], a[138:139], v[76:79] cbsz:2 abid:2
    s_waitcnt vmcnt(5)
    v_mfma_f32_4x4x4_16b_bf16 v[72:75], v[68:69], a[140:141], v[72:75] cbsz:2 abid:2
    v_mfma_f32_4x4x4_16b_bf16 v[76:79], v[68:69], a[142:143], v[76:79] cbsz:2 abid:2
    s_waitcnt vmcnt(4)
    v_mfma_f32_4x4x4_16b_bf16 v[72:75], v[70:71], a[144:145], v[72:75] cbsz:2 abid:2
    v_mfma_f32_4x4x4_16b_bf16 v[76:79], v[70:71], a[146:147], v[76:79] cbsz:2 abid:2
    s_waitcnt vmcnt(3)
    v_mfma_f32_4x4x4_16b_bf16 v[72:75], v[64:65], a[152:153], v[72:75] cbsz:2 abid:3
    v_mfma_f32_4x4x4_16b_bf16 v[76:79], v[64:65], a[154:155], v[76:79] cbsz:2 abid:3
    s_waitcnt vmcnt(2)
    v_mfma_f32_4x4x4_16b_bf16 v[72:75], v[66:67], a[156:157], v[72:75] cbsz:2 abid:3
    v_mfma_f32_4x4x4_16b_bf16 v[76:79], v[66:67], a[158:159], v[76:79] cbsz:2 abid:3
    s_waitcnt vmcnt(1)
    v_mfma_f32_4x4x4_16b_bf16 v[72:75], v[68:69], a[164:165], v[72:75] cbsz:2 abid:3
    v_mfma_f32_4x4x4_16b_bf16 v[76:79], v[68:69], a[166:167], v[76:79] cbsz:2 abid:3
    s_waitcnt vmcnt(0)
    v_mfma_f32_4x4x4_16b_bf16 v[72:75], v[70:71], a[168:169], v[72:75] cbsz:2 abid:3
    v_mfma_f32_4x4x4_16b_bf16 v[76:79], v[70:71], a[170:171], v[76:79] cbsz:2 abid:3
    s_nop 4
    v_permlane32_swap_b32 v72, v76
    v_permlane32_swap_b32 v73, v77
    v_permlane32_swap_b32 v74, v78
    v_permlane32_swap_b32 v75, v79
    v_add_f32 v72, v72, v76
    v_add_f32 v73, v73, v77
    v_add_f32 v74, v74, v78
    v_add_f32 v75, v75, v79
    s_nop 0
    v_permlane16_swap_b32 v72, v74
    v_permlane16_swap_b32 v73, v75
    v_add_f32 v72, v72, v74
    v_add_f32 v73, v73, v75
    ds_write_b64 v127, v[72:73] offset:2048
    s_waitcnt lgkmcnt(0)
    s_barrier
    ds_read_b64 v[40:41], v91 offset:2048
    ds_read_b64 v[42:43], v91 offset:2560
    ds_read_b64 v[44:45], v91 offset:3072
    ds_read_b64 v[46:47], v91 offset:3584
    s_waitcnt lgkmcnt(2)
    v_add_f32 v82, v40, v42
    v_add_f32 v83, v41, v43
    s_waitcnt lgkmcnt(0)
    v_add_f32 v44, v44, v46
    v_add_f32 v45, v45, v47
    v_add_f32 v82, v82, v44
    v_add_f32 v83, v83, v45
    v_cvt_pk_bf16_f32 v82, v82, v82
    v_cvt_pk_bf16_f32 v83, v83, v83
    s_nop 0
    v_and_b32_dpp v56, v82, v88 row_newbcast:0 row_mask:0xf bank_mask:0xf
    v_and_b32_dpp v57, v82, v89 row_newbcast:0 row_mask:0xf bank_mask:0xf
    v_and_b32_dpp v58, v83, v88 row_newbcast:0 row_mask:0xf bank_mask:0xf
    v_and_b32_dpp v59, v83, v89 row_newbcast:0 row_mask:0xf bank_mask:0xf
    v_and_b32_dpp v60, v82, v88 row_newbcast:1 row_mask:0xf bank_mask:0xf
    v_and_b32_dpp v61, v82, v89 row_newbcast:1 row_mask:0xf bank_mask:0xf
    v_and_b32_dpp v62, v83, v88 row_newbcast:1 row_mask:0xf bank_mask:0xf
    v_and_b32_dpp v63, v83, v89 row_newbcast:1 row_mask:0xf bank_mask:0xf
    v_smfmac_f32_16x16x64_bf16 v[24:27], v[56:59], v[128:135], v90
    v_and_b32_dpp v64, v82, v88 row_newbcast:2 row_mask:0xf bank_mask:0xf
    v_and_b32_dpp v65, v82, v89 row_newbcast:2 row_mask:0xf bank_mask:0xf
    v_and_b32_dpp v66, v83, v88 row_newbcast:2 row_mask:0xf bank_mask:0xf
    v_and_b32_dpp v67, v83, v89 row_newbcast:2 row_mask:0xf bank_mask:0xf
    v_smfmac_f32_16x16x64_bf16 v[24:27], v[60:63], v[136:143], v90
    v_and_b32_dpp v68, v82, v88 row_newbcast:3 row_mask:0xf bank_mask:0xf
    v_and_b32_dpp v69, v82, v89 row_newbcast:3 row_mask:0xf bank_mask:0xf
    v_and_b32_dpp v70, v83, v88 row_newbcast:3 row_mask:0xf bank_mask:0xf
    v_and_b32_dpp v71, v83, v89 row_newbcast:3 row_mask:0xf bank_mask:0xf
    v_smfmac_f32_16x16x64_bf16 v[24:27], v[64:67], v[144:151], v90
    v_and_b32_dpp v56, v82, v88 row_newbcast:4 row_mask:0xf bank_mask:0xf
    v_and_b32_dpp v57, v82, v89 row_newbcast:4 row_mask:0xf bank_mask:0xf
    v_and_b32_dpp v58, v83, v88 row_newbcast:4 row_mask:0xf bank_mask:0xf
    v_and_b32_dpp v59, v83, v89 row_newbcast:4 row_mask:0xf bank_mask:0xf
    v_smfmac_f32_16x16x64_bf16 v[24:27], v[68:71], v[152:159], v90
    v_and_b32_dpp v60, v82, v88 row_newbcast:5 row_mask:0xf bank_mask:0xf
    v_and_b32_dpp v61, v82, v89 row_newbcast:5 row_mask:0xf bank_mask:0xf
    v_and_b32_dpp v62, v83, v88 row_newbcast:5 row_mask:0xf bank_mask:0xf
    v_and_b32_dpp v63, v83, v89 row_newbcast:5 row_mask:0xf bank_mask:0xf
    v_smfmac_f32_16x16x64_bf16 v[24:27], v[56:59], v[160:167], v90
    v_and_b32_dpp v64, v82, v88 row_newbcast:6 row_mask:0xf bank_mask:0xf
    v_and_b32_dpp v65, v82, v89 row_newbcast:6 row_mask:0xf bank_mask:0xf
    v_and_b32_dpp v66, v83, v88 row_newbcast:6 row_mask:0xf bank_mask:0xf
    v_and_b32_dpp v67, v83, v89 row_newbcast:6 row_mask:0xf bank_mask:0xf
    v_smfmac_f32_16x16x64_bf16 v[24:27], v[60:63], v[168:175], v90
    v_and_b32_dpp v68, v82, v88 row_newbcast:7 row_mask:0xf bank_mask:0xf
    v_and_b32_dpp v69, v82, v89 row_newbcast:7 row_mask:0xf bank_mask:0xf
    v_and_b32_dpp v70, v83, v88 row_newbcast:7 row_mask:0xf bank_mask:0xf
    v_and_b32_dpp v71, v83, v89 row_newbcast:7 row_mask:0xf bank_mask:0xf
    v_smfmac_f32_16x16x64_bf16 v[24:27], v[64:67], v[176:183], v90
    v_and_b32_dpp v56, v82, v88 row_newbcast:8 row_mask:0xf bank_mask:0xf
    v_and_b32_dpp v57, v82, v89 row_newbcast:8 row_mask:0xf bank_mask:0xf
    v_and_b32_dpp v58, v83, v88 row_newbcast:8 row_mask:0xf bank_mask:0xf
    v_and_b32_dpp v59, v83, v89 row_newbcast:8 row_mask:0xf bank_mask:0xf
    v_smfmac_f32_16x16x64_bf16 v[24:27], v[68:71], v[184:191], v90
    v_and_b32_dpp v60, v82, v88 row_newbcast:9 row_mask:0xf bank_mask:0xf
    v_and_b32_dpp v61, v82, v89 row_newbcast:9 row_mask:0xf bank_mask:0xf
    v_and_b32_dpp v62, v83, v88 row_newbcast:9 row_mask:0xf bank_mask:0xf
    v_and_b32_dpp v63, v83, v89 row_newbcast:9 row_mask:0xf bank_mask:0xf
    v_smfmac_f32_16x16x64_bf16 v[24:27], v[56:59], v[192:199], v90
    v_and_b32_dpp v64, v82, v88 row_newbcast:10 row_mask:0xf bank_mask:0xf
    v_and_b32_dpp v65, v82, v89 row_newbcast:10 row_mask:0xf bank_mask:0xf
    v_and_b32_dpp v66, v83, v88 row_newbcast:10 row_mask:0xf bank_mask:0xf
    v_and_b32_dpp v67, v83, v89 row_newbcast:10 row_mask:0xf bank_mask:0xf
    v_smfmac_f32_16x16x64_bf16 v[24:27], v[60:63], v[200:207], v90
    v_and_b32_dpp v68, v82, v88 row_newbcast:11 row_mask:0xf bank_mask:0xf
    v_and_b32_dpp v69, v82, v89 row_newbcast:11 row_mask:0xf bank_mask:0xf
    v_and_b32_dpp v70, v83, v88 row_newbcast:11 row_mask:0xf bank_mask:0xf
    v_and_b32_dpp v71, v83, v89 row_newbcast:11 row_mask:0xf bank_mask:0xf
    v_smfmac_f32_16x16x64_bf16 v[24:27], v[64:67], v[208:215], v90
    v_and_b32_dpp v56, v82, v88 row_newbcast:12 row_mask:0xf bank_mask:0xf
    v_and_b32_dpp v57, v82, v89 row_newbcast:12 row_mask:0xf bank_mask:0xf
    v_and_b32_dpp v58, v83, v88 row_newbcast:12 row_mask:0xf bank_mask:0xf
    v_and_b32_dpp v59, v83, v89 row_newbcast:12 row_mask:0xf bank_mask:0xf
    v_smfmac_f32_16x16x64_bf16 v[24:27], v[68:71], v[216:223], v90
    v_and_b32_dpp v60, v82, v88 row_newbcast:13 row_mask:0xf bank_mask:0xf
    v_and_b32_dpp v61, v82, v89 row_newbcast:13 row_mask:0xf bank_mask:0xf
    v_and_b32_dpp v62, v83, v88 row_newbcast:13 row_mask:0xf bank_mask:0xf
    v_and_b32_dpp v63, v83, v89 row_newbcast:13 row_mask:0xf bank_mask:0xf
    v_smfmac_f32_16x16x64_bf16 v[24:27], v[56:59], v[224:231], v90
    v_and_b32_dpp v64, v82, v88 row_newbcast:14 row_mask:0xf bank_mask:0xf
    v_and_b32_dpp v65, v82, v89 row_newbcast:14 row_mask:0xf bank_mask:0xf
    v_and_b32_dpp v66, v83, v88 row_newbcast:14 row_mask:0xf bank_mask:0xf
    v_and_b32_dpp v67, v83, v89 row_newbcast:14 row_mask:0xf bank_mask:0xf
    v_smfmac_f32_16x16x64_bf16 v[24:27], v[60:63], v[232:239], v90
    v_and_b32_dpp v68, v82, v88 row_newbcast:15 row_mask:0xf bank_mask:0xf
    v_and_b32_dpp v69, v82, v89 row_newbcast:15 row_mask:0xf bank_mask:0xf
    v_and_b32_dpp v70, v83, v88 row_newbcast:15 row_mask:0xf bank_mask:0xf
    v_and_b32_dpp v71, v83, v89 row_newbcast:15 row_mask:0xf bank_mask:0xf
    v_smfmac_f32_16x16x64_bf16 v[24:27], v[64:67], v[240:247], v90
    s_nop 0
    v_smfmac_f32_16x16x64_bf16 v[24:27], v[68:71], v[248:255], v90
    s_nop 7
    v_min_u32 v72, -2, v24
    v_min_u32 v73, -2, v25
    v_min_u32 v74, -2, v26
    v_min_u32 v75, -2, v27
    s_mov_b32 exec_hi, 0
    global_store_dwordx4 v126, v[72:75], s[28:29] sc1
    s_mov_b64 exec, -1
    s_cmp_lt_u32 s2, 32
    s_cbranch_scc0 L_fin
    global_load_dwordx4 v[40:43], v105, s[28:29] offset:0 sc1
    global_load_dwordx4 v[44:47], v105, s[28:29] offset:64 sc1
    global_load_dwordx4 v[48:51], v105, s[28:29] offset:128 sc1
    global_load_dwordx4 v[52:55], v105, s[28:29] offset:192 sc1
    s_mov_b32 s57, 0x40000
L_recpoll:
    v_max3_u32 v24, v96, v97, v98
    v_max_u32 v24, v24, v99
    v_cmp_eq_u32 vcc, -1, v24
    s_nop 4
    s_cbranch_vccz L_recok
    global_load_dwordx2 v[96:97], v102, s[28:29] sc1
    global_load_dwordx2 v[98:99], v103, s[28:29] sc1
    s_sub_u32 s57, s57, 1
    s_waitcnt vmcnt(0)
    s_cmp_lg_u32 s57, 0
    s_cbranch_scc1 L_recpoll
L_recok:
    v_mov_b32 v80, v96
    s_nop 1
    v_max_f32_dpp v80, v80, v80 quad_perm:[1,0,3,2] row_mask:0xf bank_mask:0xf
    s_nop 1
    v_max_f32_dpp v80, v80, v80 quad_perm:[2,3,0,1] row_mask:0xf bank_mask:0xf
    s_nop 1
    v_max_f32_dpp v80, v80, v80 row_half_mirror row_mask:0xf bank_mask:0xf
    v_sub_f32 v106, v96, v80
    v_mul_f32 v106, 0x3fb8aa3b, v106
    v_exp_f32 v106, v106
    v_add_f32 v98, v98, v99
    v_mul_f32 v81, v106, v97
    v_lshlrev_b32 v101, 16, v101
    v_lshlrev_b32 v100, 16, v100
    v_add_f32_dpp v81, v81, v81 quad_perm:[1,0,3,2] row_mask:0xf bank_mask:0xf
    v_cvt_pk_bf16_f32 v98, v98, v98
    v_and_b32 v98, 0xffff0000, v98
    v_add_f32_dpp v81, v81, v81 quad_perm:[2,3,0,1] row_mask:0xf bank_mask:0xf
    v_add_f32 v98, v98, v101
    v_cvt_pk_bf16_f32 v98, v98, v98
    v_add_f32_dpp v81, v81, v81 row_half_mirror row_mask:0xf bank_mask:0xf
    v_and_b32 v98, 0xffff0000, v98
    v_rcp_f32 v81, v81
    s_lshl_b32 s55, s3, 6
    v_lshrrev_b32 v7, 4, v0
    v_lshlrev_b32 v7, 2, v7
    v_and_b32 v123, 3, v0
    v_mul_f32 v106, v106, v81
    v_lshl_or_b32 v7, v123, 4, v7
    v_or_b32 v7, s55, v7
    v_and_b32 v124, 15, v0
    v_lshlrev_b32 v124, 2, v124
    v_add_u32 v124, 4224, v124
    s_waitcnt vmcnt(0)
    s_mov_b32 s57, 0x40000
    s_branch L_check
L_poll:
    global_load_dwordx4 v[40:43], v105, s[28:29] offset:0 sc1
    global_load_dwordx4 v[44:47], v105, s[28:29] offset:64 sc1
    global_load_dwordx4 v[48:51], v105, s[28:29] offset:128 sc1
    global_load_dwordx4 v[52:55], v105, s[28:29] offset:192 sc1
L_check:
    s_sub_u32 s57, s57, 1
    s_cmp_eq_u32 s57, 0
    s_cbranch_scc1 L_polldone
    s_waitcnt vmcnt(8)
    v_max3_u32 v24, v40, v41, v42
    v_max3_u32 v25, v44, v45, v46
    v_max3_u32 v26, v48, v49, v50
    v_max3_u32 v27, v52, v53, v54
    v_max3_u32 v24, v24, v43, v47
    v_max3_u32 v25, v25, v51, v55
    v_max3_u32 v24, v24, v26, v27
    v_max_u32 v24, v24, v25
    v_cmp_eq_u32 vcc, -1, v24
    s_nop 1
    s_and_b64 exec, exec, vcc
    s_cbranch_scc0 L_polldone
    s_bcnt1_i32_b64 s55, vcc
    s_cmp_le_u32 s55, 32
    s_cbranch_scc1 L_poll
    s_waitcnt vmcnt(0)
    s_sleep 8
    global_load_dwordx4 v[40:43], v105, s[28:29] offset:0 sc1
    global_load_dwordx4 v[44:47], v105, s[28:29] offset:64 sc1
    global_load_dwordx4 v[48:51], v105, s[28:29] offset:128 sc1
    global_load_dwordx4 v[52:55], v105, s[28:29] offset:192 sc1
    s_waitcnt vmcnt(0)
    s_branch L_check
L_polldone:
    s_mov_b64 exec, -1
    v_mul_f32_dpp v72, v106, v40 quad_perm:[0,0,0,0] row_mask:0xf bank_mask:0xf
    v_mul_f32_dpp v73, v106, v41 quad_perm:[0,0,0,0] row_mask:0xf bank_mask:0xf
    v_mul_f32_dpp v74, v106, v42 quad_perm:[0,0,0,0] row_mask:0xf bank_mask:0xf
    v_mul_f32_dpp v75, v106, v43 quad_perm:[0,0,0,0] row_mask:0xf bank_mask:0xf
    v_fmac_f32_dpp v72, v106, v44 quad_perm:[1,1,1,1] row_mask:0xf bank_mask:0xf
    v_fmac_f32_dpp v73, v106, v45 quad_perm:[1,1,1,1] row_mask:0xf bank_mask:0xf
    v_fmac_f32_dpp v74, v106, v46 quad_perm:[1,1,1,1] row_mask:0xf bank_mask:0xf
    v_fmac_f32_dpp v75, v106, v47 quad_perm:[1,1,1,1] row_mask:0xf bank_mask:0xf
    v_fmac_f32_dpp v72, v106, v48 quad_perm:[2,2,2,2] row_mask:0xf bank_mask:0xf
    v_fmac_f32_dpp v73, v106, v49 quad_perm:[2,2,2,2] row_mask:0xf bank_mask:0xf
    v_fmac_f32_dpp v74, v106, v50 quad_perm:[2,2,2,2] row_mask:0xf bank_mask:0xf
    v_fmac_f32_dpp v75, v106, v51 quad_perm:[2,2,2,2] row_mask:0xf bank_mask:0xf
    v_fmac_f32_dpp v72, v106, v52 quad_perm:[3,3,3,3] row_mask:0xf bank_mask:0xf
    v_fmac_f32_dpp v73, v106, v53 quad_perm:[3,3,3,3] row_mask:0xf bank_mask:0xf
    v_fmac_f32_dpp v74, v106, v54 quad_perm:[3,3,3,3] row_mask:0xf bank_mask:0xf
    v_fmac_f32_dpp v75, v106, v55 quad_perm:[3,3,3,3] row_mask:0xf bank_mask:0xf
    v_add_f32_dpp v72, v72, v72 row_ror:8 row_mask:0xf bank_mask:0xf
    v_add_f32_dpp v73, v73, v73 row_ror:8 row_mask:0xf bank_mask:0xf
    v_add_f32_dpp v74, v74, v74 row_ror:8 row_mask:0xf bank_mask:0xf
    v_add_f32_dpp v75, v75, v75 row_ror:8 row_mask:0xf bank_mask:0xf
    v_add_f32_dpp v72, v72, v72 row_ror:4 row_mask:0xf bank_mask:0xf
    v_add_f32_dpp v73, v73, v73 row_ror:4 row_mask:0xf bank_mask:0xf
    v_add_f32_dpp v74, v74, v74 row_ror:4 row_mask:0xf bank_mask:0xf
    v_add_f32_dpp v75, v75, v75 row_ror:4 row_mask:0xf bank_mask:0xf
    s_nop 0
    v_permlane32_swap_b32 v72, v74
    v_permlane32_swap_b32 v73, v75
    v_add_f32 v72, v72, v74
    v_add_f32 v73, v73, v75
    s_nop 1
    v_permlane16_swap_b32 v72, v73
    v_add_f32 v72, v72, v73
    ds_write_b32 v7, v72 offset:4224
    s_waitcnt lgkmcnt(0)
    s_barrier
    s_cmp_lg_u32 s3, 0
    s_cbranch_scc1 L_fin
    ds_read2_b32 v[72:73], v124 offset0:0 offset1:16
    ds_read2_b32 v[74:75], v124 offset0:32 offset1:48
    s_waitcnt lgkmcnt(0)
    v_add_f32 v72, v72, v73
    v_add_f32 v74, v74, v75
    v_add_f32 v72, v72, v74
    v_cvt_pk_bf16_f32 v72, v72, v72
    v_and_b32 v72, 0xffff0000, v72
    v_add_f32 v72, v72, v100
    v_cvt_pk_bf16_f32 v72, v72, v72
    v_and_b32 v72, 0xffff0000, v72
    v_add_f32 v72, v72, v98
    v_cvt_pk_bf16_f32 v72, v72, v72
    s_mov_b64 exec, 0xffff
    global_store_short v104, v72, s[24:25]
    s_mov_b64 exec, -1
L_fin:
L_end:
    s_endpgm
.section .rodata,"a"
.p2align 6
.amdhsa_kernel parallel_sum__mha_block_cached__mixer_token_mlp__decode_kernel
  .amdhsa_next_free_vgpr 512
  .amdhsa_next_free_sgpr 96
  .amdhsa_accum_offset 256
  .amdhsa_group_segment_fixed_size 0
  .amdhsa_kernarg_size 104
  .amdhsa_user_sgpr_count 2
  .amdhsa_user_sgpr_kernarg_segment_ptr 1
  .amdhsa_system_sgpr_workgroup_id_x 1
  .amdhsa_float_denorm_mode_32 3
.end_amdhsa_kernel
```
